```python
import torch

def _softmax(x, axis=-1):
    return torch.softmax(x, dim=axis)
def _gelu(x):
    return torch.nn.functional.gelu(x, approximate="tanh")
def _silu(x):
    return torch.nn.functional.silu(x)
def _sigmoid(x):
    return torch.sigmoid(x)
def _layernorm(x, axis=-1, eps=1e-5):
    m = x.mean(dim=axis, keepdim=True)
    v = x.var(dim=axis, keepdim=True, unbiased=False)
    return (x - m) / torch.sqrt(v + eps)
def _scatter_add(tgt, idx, src, axis=0):
    return tgt.clone().index_add_(axis, idx, src)
def _segment_sum(src, seg, n):
    out = torch.zeros((n,) + src.shape[1:], dtype=src.dtype)
    return out.index_add_(0, seg, src)
def _pad(x, pw):
    flat = tuple(v for pair in reversed(pw) for v in pair)
    return torch.nn.functional.pad(x, flat)

kernel_name = 'parallel_sum__sliding_block_cached__dense_activation_silu__decode'

def setup_inputs():

    _w = (lambda a: (lambda t: t.to(torch.bfloat16) if t.is_floating_point() else t)(torch.as_tensor(a)))
    def _A_setup():
        B, Sq, D = 4, 1, 576
        Hq, Hkv, Sk, Dh = 32, 16, 8192, 128
        assert Hq % Hkv == 0, (Hq, Hkv)
        return {
            "x": _w((lambda *s: torch.randn(*s, dtype=torch.bfloat16) * 0.05)(B, Sq, D)),
            "k_cache": _w((lambda *s: torch.randn(*s, dtype=torch.bfloat16) * 3.2)(B, Hkv, Sk, Dh)),
            "v_cache": _w((lambda *s: torch.randn(*s, dtype=torch.bfloat16) * 0.8)(B, Hkv, Sk, Dh)),
            "wq": _w((lambda *s: torch.randn(*s, dtype=torch.bfloat16) * 3.2)(D, Hq * Dh) * (D ** -0.5)),
            "wo": _w((lambda *s: torch.randn(*s, dtype=torch.bfloat16) * 0.8)(Hq * Dh, D) * ((Hq * Dh) ** -0.5)),
        }
    _A_in = _A_setup()

    def _B_setup():
        B, S, D, F = 4, 1, 576, 4608
        return {
            "x": _w((lambda *s: torch.randn(*s, dtype=torch.bfloat16) * 0.05)(B, S, D)),
            "w1": _w((lambda *s: torch.randn(*s, dtype=torch.bfloat16) * 3.2)(D, F) * (D ** -0.5)),
            "w2": _w((lambda *s: torch.randn(*s, dtype=torch.bfloat16) * 0.4)(F, D) * (F ** -0.5)),
        }
    _B_in = _B_setup()

    return {
        "A_x": _A_in["x"],
        "A_k_cache": _A_in["k_cache"],
        "A_v_cache": _A_in["v_cache"],
        "A_wq": _A_in["wq"],
        "A_wo": _A_in["wo"],
        "B_x": _B_in["x"],
        "B_w1": _B_in["w1"],
        "B_w2": _B_in["w2"],
    }

def reference(A_x, A_k_cache, A_v_cache, A_wq, A_wo, B_x, B_w1, B_w2):
    def _A_ref(x, k_cache, v_cache, wq, wo):
        B, Sq, D = x.shape
        Hq, Dh = 32, 128
        Hkv, Sk = k_cache.shape[1], k_cache.shape[2]
        W = min(4096, max(256, Sk // 4))
        rep = Hq // Hkv
        q = (lambda x, *d: x.permute(*d))((x @ wq).reshape(B, Sq, Hq, Dh), 0, 2, 1, 3)
        k = (lambda x, n, axis: torch.repeat_interleave(x, n, dim=axis))(k_cache[:, :, Sk - W:, :], rep, axis=1)
        v = (lambda x, n, axis: torch.repeat_interleave(x, n, dim=axis))(v_cache[:, :, Sk - W:, :], rep, axis=1)
        scores = torch.einsum("bhqd,bhkd->bhqk", q, k) * (Dh ** -0.5)
        p = _softmax(scores, axis=-1)
        o = torch.einsum("bhqk,bhkd->bhqd", p, v)
        return (lambda x, *d: x.permute(*d))(o, 0, 2, 1, 3).reshape(B, Sq, Hq * Dh) @ wo

    def _B_ref(x, w1, w2):
        h = torch.einsum("bsd,df->bsf", x, w1)
        h = _silu(h)
        out = torch.einsum("bsf,fd->bsd", h, w2)
        return out

    x = A_x
    xn = _layernorm(x, axis=-1)
    return x + _A_ref(xn, A_k_cache, A_v_cache, A_wq, A_wo) + _B_ref(xn, B_w1, B_w2)
```

```asm
; @launch grid=(256,1,1) block=(512,1,1) lds=124224
.amdgcn_target "amdgcn-amd-amdhsa--gfx950"
.text
.globl parallel_sum__sliding_block_cached__dense_activation_silu__decode_kernel
.p2align 8
.type parallel_sum__sliding_block_cached__dense_activation_silu__decode_kernel,@function
parallel_sum__sliding_block_cached__dense_activation_silu__decode_kernel:
  s_load_dwordx16 s[4:19], s[0:1], 0
  s_getpc_b64 s[36:37]
  s_lshr_b32 s38, s2, 3
  v_lshl_add_u32 v1, s38, 9, v0
  s_cmpk_ge_u32 s2, 256
  s_cbranch_scc1 L_exit
  global_load_ubyte v255, v1, s[36:37]
  s_load_dwordx2 s[24:25], s[0:1], 80
  s_lshr_b32 s29, s2, 5
  s_or_b32 s30, s29, 3
  s_and_b32 s29, s29, 3
  s_and_b32 s34, s2, 31
  s_lshl3_add_u32 s34, s34, s30
  s_lshl_b32 s34, s34, 7
  s_or_b32 s34, s34, s29
  s_lshl_b32 s93, s34, 12
  v_lshlrev_b32 v3, 4, v0
  v_xor_b32 v3, s93, v3
  v_cmp_lt_u32 vcc, 0xff, v0
  s_waitcnt lgkmcnt(0)
  s_cbranch_vccz L_nopre
  global_load_dwordx4 v[136:139], v3, s[8:9] nt
  v_xor_b32 v3, 0x5000, v3
  global_load_dwordx4 v[140:143], v3, s[8:9] nt
L_nopre:
  s_load_dwordx2 s[20:21], s[0:1], 64
  v_lshrrev_b32 v1, 6, v0
  v_and_b32 v0, 63, v0
  v_readfirstlane_b32 s3, v1
  s_and_b32 s28, s2, 7
  s_lshr_b32 s30, s2, 7
  s_bfe_u32 s31, s2, 0x20003
  s_lshl1_add_u32 s30, s28, s30
  s_lshl2_add_u32 s31, s31, s29
  s_lshl4_add_u32 s29, s30, s31
  v_lshlrev_b32 v2, 4, v0
  s_mov_b32 s79, s30
  s_mov_b32 s38, 0xdc985410
  s_mov_b32 s39, 0xfba7632e
  s_mov_b32 s40, 0x40303030
  s_mov_b32 s41, 0xcc6c6c68
  s_lshl_b32 s36, s31, 2
  s_lshr_b64 s[38:39], s[38:39], s36
  s_lshr_b64 s[40:41], s[40:41], s36
  s_and_b32 s45, s38, 15
  s_and_b32 s46, s40, 15
  s_cmp_lt_u32 s31, 9
  s_cselect_b32 s94, 4, 6
  s_cmp_lt_u32 s31, 6
  s_cselect_b32 s94, 3, s94
  s_cmp_lt_u32 s3, 4
  s_cbranch_scc1 L_aux
  v_lshrrev_b32 v3, 3, v0
  v_and_b32 v4, 6, v3
  v_and_b32 v5, 7, v0
  v_xor_b32 v4, v4, v5
  v_lshlrev_b32 v4, 4, v4
  v_lshl_add_u32 v5, v3, 13, v4
  s_lshl_b32 s38, s46, 2
  s_and_b32 s46, s3, 3
  s_add_u32 s38, s38, s46
  s_lshl_b32 s38, s38, 16
  s_lshr_b32 s39, s45, 2
  s_lshl2_add_u32 s39, s79, s39
  s_lshl_b32 s39, s39, 7
  s_add_u32 s38, s38, s39
  s_lshl_b32 m0, s46, 10
  s_mov_b32 s42, 4718592
  s_mov_b32 s43, 0x20000
  s_mov_b64 s[40:41], s[10:11]
  buffer_load_dwordx4 v5, s[40:43], s38 offen nt lds
  s_add_u32 m0, m0, 4096
  s_add_u32 s38, s38, 262144
  buffer_load_dwordx4 v5, s[40:43], s38 offen nt lds
  s_add_u32 m0, m0, 4096
  s_add_u32 s38, s38, 262144
  buffer_load_dwordx4 v5, s[40:43], s38 offen nt lds
  s_add_u32 m0, m0, 4096
  s_add_u32 s38, s38, 262144
  s_setprio 2
  s_and_b32 s35, s30, 1
  s_mul_i32 s35, s35, 7
  s_add_u32 s35, s35, s31
  s_sub_u32 s33, s35, 9
  s_sub_u32 s34, s35, 18
  s_lshl_b32 s34, s34, 1
  s_cmp_lt_u32 s35, 18
  s_cselect_b32 s32, 2, 3
  s_cselect_b32 s33, s33, s34
  s_cmp_lt_u32 s31, 9
  s_cselect_b32 s32, 1, s32
  s_cselect_b32 s33, s31, s33
  s_mov_b32 s26, 1900544
  s_mov_b32 s27, 0x20000
  s_movk_i32 s22, 4608
  s_mov_b32 s23, s27
  s_mov_b32 s59, 0
  s_mov_b32 s57, 1069066811
  v_mov_b32 v7, 109696
  v_lshl_add_u32 v250, s46, 2, v7
  v_mov_b32 v251, 0xff
  s_and_b32 s47, s93, 0x7f000
  s_and_b32 s93, s93, 0xfff80000
  s_add_u32 s96, s6, s93
  s_addc_u32 s97, s7, 0
  s_mov_b32 s98, 0x80000
  s_mov_b32 s99, s43
  s_add_u32 s8, s8, s93
  s_addc_u32 s9, s9, 0
  s_mov_b32 s10, s98
  s_mov_b32 s11, s43
  v_min_u32 v252, 31, v0
  v_lshlrev_b32 v252, 2, v252
  s_lshl2_add_u32 s100, s28, s46
  s_lshl_b32 s100, s100, 8
  s_add_u32 s100, s100, 40960
  s_and_b32 s94, s29, 31
  s_lshl2_add_u32 s101, s94, s100
  s_mov_b32 s95, 0
  s_waitcnt lgkmcnt(0)
  s_load_dword s58, s[24:25], 0
  s_cmp_eq_u32 s32, 1
  s_cbranch_scc0 L_eF
  s_cmp_lt_u32 s31, 6
  s_cbranch_scc1 L_nq4
  s_waitcnt vmcnt(4)
  buffer_load_dwordx4 v5, s[40:43], s38 offen nt lds
  s_add_u32 m0, m0, 4096
  s_add_u32 s38, s38, 262144
L_nq4:
  s_mul_i32 s44, s30, 9
  s_add_u32 s44, s44, s31
  s_and_b32 s38, s44, 1
  s_mul_i32 s38, s38, 36
  s_add_u32 s38, s38, s46
  s_mul_i32 s38, s38, 73728
  s_lshr_b32 s39, s44, 1
  s_lshl_b32 s39, s39, 7
  s_add_u32 s38, s38, s39
  s_lshl_b32 s39, s46, 10
  s_add_u32 m0, s39, 18432
  s_mov_b32 s42, 5308416
  v_mul_u32_u24 v6, 9216, v3
  v_add_u32 v6, v6, v4
  s_mov_b64 s[40:41], s[16:17]
  s_waitcnt vmcnt(4)
  buffer_load_dwordx4 v6, s[40:43], s38 offen nt lds
  s_add_u32 m0, m0, 4096
  s_add_u32 s38, s38, 294912
  s_waitcnt vmcnt(4)
  buffer_load_dwordx4 v6, s[40:43], s38 offen nt lds
  s_add_u32 m0, m0, 4096
  s_add_u32 s38, s38, 294912
  s_barrier
  s_movk_i32 s44, 6
L_w1:
  s_getreg_b32 s39, hwreg(HW_REG_IB_STS, 0, 4)
  s_cmp_le_u32 s39, 4
  s_cbranch_scc1 L_b1
  s_sub_u32 s44, s44, 1
  s_cbranch_scc0 L_w1
L_b1:
  s_waitcnt vmcnt(7)
  buffer_load_dwordx4 v6, s[40:43], s38 offen nt lds
  s_add_u32 m0, m0, 4096
  s_add_u32 s38, s38, 294912
  s_movk_i32 s44, 6
L_w2:
  s_getreg_b32 s39, hwreg(HW_REG_IB_STS, 0, 4)
  s_cmp_le_u32 s39, 4
  s_cbranch_scc1 L_b2
  s_sub_u32 s44, s44, 1
  s_cbranch_scc0 L_w2
L_b2:
  s_waitcnt vmcnt(7)
  buffer_load_dwordx4 v6, s[40:43], s38 offen nt lds
  s_add_u32 m0, m0, 4096
  s_add_u32 s38, s38, 294912
  s_movk_i32 s44, 6
L_w3:
  s_getreg_b32 s39, hwreg(HW_REG_IB_STS, 0, 4)
  s_cmp_le_u32 s39, 4
  s_cbranch_scc1 L_b3
  s_sub_u32 s44, s44, 1
  s_cbranch_scc0 L_w3
L_b3:
  s_waitcnt vmcnt(7)
  buffer_load_dwordx4 v6, s[40:43], s38 offen nt lds
  s_add_u32 m0, m0, 4096
  s_add_u32 s38, s38, 294912
  s_movk_i32 s44, 6
L_w4:
  s_getreg_b32 s39, hwreg(HW_REG_IB_STS, 0, 4)
  s_cmp_le_u32 s39, 4
  s_cbranch_scc1 L_b4
  s_sub_u32 s44, s44, 1
  s_cbranch_scc0 L_w4
L_b4:
  s_waitcnt vmcnt(7)
  buffer_load_dwordx4 v6, s[40:43], s38 offen nt lds
  s_add_u32 m0, m0, 4096
  s_add_u32 s38, s38, 294912
  s_movk_i32 s44, 6
L_w5:
  s_getreg_b32 s39, hwreg(HW_REG_IB_STS, 0, 4)
  s_cmp_le_u32 s39, 4
  s_cbranch_scc1 L_b5
  s_sub_u32 s44, s44, 1
  s_cbranch_scc0 L_w5
L_b5:
  s_waitcnt vmcnt(7)
  buffer_load_dwordx4 v6, s[40:43], s38 offen nt lds
  s_add_u32 m0, m0, 4096
  s_add_u32 s38, s38, 294912
  s_movk_i32 s44, 6
L_w6:
  s_getreg_b32 s39, hwreg(HW_REG_IB_STS, 0, 4)
  s_cmp_le_u32 s39, 4
  s_cbranch_scc1 L_b6
  s_sub_u32 s44, s44, 1
  s_cbranch_scc0 L_w6
L_b6:
  s_waitcnt vmcnt(7)
  buffer_load_dwordx4 v6, s[40:43], s38 offen nt lds
  s_add_u32 m0, m0, 4096
  s_add_u32 s38, s38, 294912
  ds_write_b32 v250, v251 offset:64
  s_movk_i32 s44, 6
L_w7:
  s_getreg_b32 s39, hwreg(HW_REG_IB_STS, 0, 4)
  s_cmp_le_u32 s39, 4
  s_cbranch_scc1 L_b7
  s_sub_u32 s44, s44, 1
  s_cbranch_scc0 L_w7
L_b7:
  s_waitcnt vmcnt(7)
  buffer_load_dwordx4 v6, s[40:43], s38 offen nt lds
  s_add_u32 m0, m0, 4096
  s_add_u32 s38, s38, 294912
  v_lshrrev_b32 v3, 3, v0
  v_and_b32 v4, 6, v3
  v_and_b32 v5, 7, v0
  v_xor_b32 v4, v4, v5
  v_lshlrev_b32 v4, 4, v4
  v_mul_u32_u24 v3, 1152, v3
  v_add_u32 v3, v3, v4
  s_mov_b32 s51, 0x20000
  s_cmp_eq_u32 s32, 1
  s_cbranch_scc0 L_tko_f
  s_mov_b64 s[48:49], s[12:13]
  s_mov_b32 s50, 4718592
  s_lshl_b32 s54, s79, 2
  s_add_u32 s54, s54, s46
  s_mov_b32 s55, 0
  s_mov_b32 s36, s33
  s_branch L_tko_c
L_tko_f:
  s_mov_b64 s[48:49], s[18:19]
  s_and_b32 s54, s46, 1
  s_add_u32 s54, s54, 4
  s_lshr_b32 s36, s46, 1
  s_cmp_eq_u32 s32, 2
  s_cselect_b32 s54, s46, s54
  s_cselect_b32 s36, 0, s36
  s_add_u32 s36, s36, s33
  s_cmp_lt_u32 s36, 9
  s_cselect_b32 s50, 5308416, 0
  s_lshr_b32 s55, s54, 1
  s_mul_i32 s55, s55, 6
  s_and_b32 s37, s54, 1
  s_add_u32 s55, s55, s37
  s_mul_i32 s37, s28, 18
  s_add_u32 s55, s55, s37
  s_add_u32 s55, s55, 2
  s_mul_i32 s54, s54, 3
  s_add_u32 s54, s54, s37
  s_add_u32 s54, s54, 1
  s_lshr_b32 s54, s54, 1
L_tko_c:
  s_lshl_b32 s36, s36, 7
  s_mul_i32 s52, s54, 73728
  s_add_u32 s52, s52, s36
  s_mul_i32 s53, s55, 36864
  s_add_u32 s53, s53, s36
  s_mul_i32 s36, s46, 12288
  s_add_u32 s36, s36, 55296
  s_movk_i32 s44, 3
L_w8:
  s_getreg_b32 s39, hwreg(HW_REG_IB_STS, 0, 4)
  s_cmp_le_u32 s39, 4
  s_cbranch_scc1 L_b8
  s_sub_u32 s44, s44, 1
  s_cbranch_scc0 L_w8
L_b8:
  s_waitcnt vmcnt(7)
  s_add_u32 m0, s36, 0
  s_add_u32 s37, s52, 0
  buffer_load_dwordx4 v3, s[48:51], s37 offen nt lds
  s_movk_i32 s44, 6
L_w9:
  s_getreg_b32 s39, hwreg(HW_REG_IB_STS, 0, 4)
  s_cmp_le_u32 s39, 4
  s_cbranch_scc1 L_b9
  s_sub_u32 s44, s44, 1
  s_cbranch_scc0 L_w9
L_b9:
  s_waitcnt vmcnt(7)
  s_add_u32 m0, s36, 1024
  s_add_u32 s37, s52, 9216
  buffer_load_dwordx4 v3, s[48:51], s37 offen nt lds
  s_branch L_eE
L_eF:
  s_waitcnt vmcnt(4)
  buffer_load_dwordx4 v5, s[40:43], s38 offen nt lds
  s_add_u32 m0, m0, 4096
  s_add_u32 s38, s38, 262144
  s_waitcnt vmcnt(4)
  buffer_load_dwordx4 v5, s[40:43], s38 offen nt lds
  s_add_u32 m0, m0, 4096
  s_add_u32 s38, s38, 262144
  s_barrier
  s_waitcnt vmcnt(4)
  buffer_load_dwordx4 v5, s[40:43], s38 offen nt lds
  s_add_u32 m0, m0, 4096
  s_add_u32 s38, s38, 262144
  v_lshrrev_b32 v3, 3, v0
  v_and_b32 v4, 6, v3
  v_and_b32 v5, 7, v0
  v_xor_b32 v4, v4, v5
  v_lshlrev_b32 v4, 4, v4
  v_mul_u32_u24 v3, 1152, v3
  v_add_u32 v3, v3, v4
  s_mov_b32 s51, 0x20000
  s_cmp_eq_u32 s32, 1
  s_cbranch_scc0 L_tkf_f
  s_mov_b64 s[48:49], s[12:13]
  s_mov_b32 s50, 4718592
  s_lshl_b32 s54, s79, 2
  s_add_u32 s54, s54, s46
  s_mov_b32 s55, 0
  s_mov_b32 s36, s33
  s_branch L_tkf_c
L_tkf_f:
  s_mov_b64 s[48:49], s[18:19]
  s_and_b32 s54, s46, 1
  s_add_u32 s54, s54, 4
  s_lshr_b32 s36, s46, 1
  s_cmp_eq_u32 s32, 2
  s_cselect_b32 s54, s46, s54
  s_cselect_b32 s36, 0, s36
  s_add_u32 s36, s36, s33
  s_cmp_lt_u32 s36, 9
  s_cselect_b32 s50, 5308416, 0
  s_lshr_b32 s55, s54, 1
  s_mul_i32 s55, s55, 6
  s_and_b32 s37, s54, 1
  s_add_u32 s55, s55, s37
  s_mul_i32 s37, s28, 18
  s_add_u32 s55, s55, s37
  s_add_u32 s55, s55, 2
  s_mul_i32 s54, s54, 3
  s_add_u32 s54, s54, s37
  s_add_u32 s54, s54, 1
  s_lshr_b32 s54, s54, 1
L_tkf_c:
  s_lshl_b32 s36, s36, 7
  s_mul_i32 s52, s54, 73728
  s_add_u32 s52, s52, s36
  s_mul_i32 s53, s55, 36864
  s_add_u32 s53, s53, s36
  s_mul_i32 s36, s46, 12288
  s_add_u32 s36, s36, 55296
  s_movk_i32 s44, 3
L_w10:
  s_getreg_b32 s39, hwreg(HW_REG_IB_STS, 0, 4)
  s_cmp_le_u32 s39, 4
  s_cbranch_scc1 L_b10
  s_sub_u32 s44, s44, 1
  s_cbranch_scc0 L_w10
L_b10:
  s_waitcnt vmcnt(7)
  s_add_u32 m0, s36, 0
  s_add_u32 s37, s52, 0
  buffer_load_dwordx4 v3, s[48:51], s37 offen nt lds
  s_movk_i32 s44, 6
L_w11:
  s_getreg_b32 s39, hwreg(HW_REG_IB_STS, 0, 4)
  s_cmp_le_u32 s39, 4
  s_cbranch_scc1 L_b11
  s_sub_u32 s44, s44, 1
  s_cbranch_scc0 L_w11
L_b11:
  s_waitcnt vmcnt(7)
  s_add_u32 m0, s36, 1024
  s_add_u32 s37, s52, 9216
  buffer_load_dwordx4 v3, s[48:51], s37 offen nt lds
  s_movk_i32 s44, 6
L_w12:
  s_getreg_b32 s39, hwreg(HW_REG_IB_STS, 0, 4)
  s_cmp_le_u32 s39, 4
  s_cbranch_scc1 L_b12
  s_sub_u32 s44, s44, 1
  s_cbranch_scc0 L_w12
L_b12:
  s_waitcnt vmcnt(7)
  s_add_u32 m0, s36, 2048
  s_add_u32 s37, s52, 18432
  buffer_load_dwordx4 v3, s[48:51], s37 offen nt lds
  s_movk_i32 s44, 6
L_w13:
  s_getreg_b32 s39, hwreg(HW_REG_IB_STS, 0, 4)
  s_cmp_le_u32 s39, 4
  s_cbranch_scc1 L_b13
  s_sub_u32 s44, s44, 1
  s_cbranch_scc0 L_w13
L_b13:
  s_waitcnt vmcnt(7)
  s_add_u32 m0, s36, 3072
  s_add_u32 s37, s52, 27648
  buffer_load_dwordx4 v3, s[48:51], s37 offen nt lds
  s_movk_i32 s44, 6
L_w14:
  s_getreg_b32 s39, hwreg(HW_REG_IB_STS, 0, 4)
  s_cmp_le_u32 s39, 4
  s_cbranch_scc1 L_b14
  s_sub_u32 s44, s44, 1
  s_cbranch_scc0 L_w14
L_b14:
  s_waitcnt vmcnt(7)
  s_add_u32 m0, s36, 4096
  s_add_u32 s37, s52, 36864
  buffer_load_dwordx4 v3, s[48:51], s37 offen nt lds
  s_movk_i32 s44, 6
L_w15:
  s_getreg_b32 s39, hwreg(HW_REG_IB_STS, 0, 4)
  s_cmp_le_u32 s39, 4
  s_cbranch_scc1 L_b15
  s_sub_u32 s44, s44, 1
  s_cbranch_scc0 L_w15
L_b15:
  s_waitcnt vmcnt(7)
  s_add_u32 m0, s36, 5120
  s_add_u32 s37, s52, 46080
  buffer_load_dwordx4 v3, s[48:51], s37 offen nt lds
L_eE:
  s_lshl_b32 s18, s3, 10
  s_xor_b32 s17, s47, s18
  v_bfe_u32 v3, v0, 2, 2
  v_lshlrev_b32 v3, 8, v3
  v_lshrrev_b32 v4, 4, v0
  v_lshlrev_b32 v4, 6, v4
  v_and_b32 v5, 3, v0
  v_lshl_add_u32 v4, v5, 4, v4
  v_add_u32 v3, v3, v4
  s_waitcnt lgkmcnt(0)
  s_add_u32 s58, s58, 0x9E3779B9
  s_and_b32 s60, s58, 0xff
  s_bfe_u32 s61, s58, 0x80008
  s_bfe_u32 s62, s58, 0x80010
  s_lshr_b32 s63, s58, 24
  s_xor_b32 s45, s17, 0
  s_movk_i32 s44, 6
L_w16:
  s_getreg_b32 s39, hwreg(HW_REG_IB_STS, 0, 4)
  s_cmp_le_u32 s39, 4
  s_cbranch_scc1 L_b16
  s_sub_u32 s44, s44, 1
  s_cbranch_scc0 L_w16
L_b16:
  s_waitcnt vmcnt(7)
  buffer_load_dwordx4 v[8:11], v3, s[96:99], s45 offen nt
  v_bfe_u32 v5, v0, 3, 1
  v_lshl_add_u32 v4, v5, 8, v4
  v_add_u32 v4, 109184, v4
  v_and_b32 v6, 1, v0
  s_xor_b32 s45, s17, 20480
  s_movk_i32 s44, 8
L_w17:
  s_getreg_b32 s39, hwreg(HW_REG_IB_STS, 0, 4)
  s_cmp_le_u32 s39, 4
  s_cbranch_scc1 L_b17
  s_sub_u32 s44, s44, 1
  s_cbranch_scc0 L_w17
L_b17:
  s_waitcnt vmcnt(7)
  buffer_load_dwordx4 v[12:15], v3, s[96:99], s45 offen nt
  ds_write_b32 v250, v251 offset:64
  s_add_u32 s94, s58, 0
  v_mov_b32 v253, s94
  s_mov_b64 exec, 1
  buffer_store_dword v253, v252, s[24:27], s101 offen
  s_mov_b64 exec, -1
  buffer_load_dword v254, v252, s[24:27], s100 offen sc1
  v_lshlrev_b32 v6, 4, v6
  v_mov_b32 v1, 0xffff
  v_lshlrev_b32 v6, v6, v1
  v_bfe_u32 v1, v0, 1, 2
  s_xor_b32 s45, s17, 40960
  s_movk_i32 s44, 7
L_w18:
  s_getreg_b32 s39, hwreg(HW_REG_IB_STS, 0, 4)
  s_cmp_le_u32 s39, 6
  s_cbranch_scc1 L_b18
  s_sub_u32 s44, s44, 1
  s_cbranch_scc0 L_w18
L_b18:
  s_waitcnt vmcnt(9)
  buffer_load_dwordx4 v[16:19], v3, s[96:99], s45 offen nt
  v_cmp_eq_u32 s[80:81], 0, v1
  v_cmp_eq_u32 s[82:83], 1, v1
  v_cmp_eq_u32 s[84:85], 2, v1
  v_cmp_eq_u32 s[86:87], 3, v1
  s_xor_b32 s45, s17, 61440
  s_movk_i32 s44, 8
L_w19:
  s_getreg_b32 s39, hwreg(HW_REG_IB_STS, 0, 4)
  s_cmp_le_u32 s39, 6
  s_cbranch_scc1 L_b19
  s_sub_u32 s44, s44, 1
  s_cbranch_scc0 L_w19
L_b19:
  s_waitcnt vmcnt(9)
  buffer_load_dwordx4 v[20:23], v3, s[96:99], s45 offen nt
  v_cndmask_b32 v236, 0, v6, s[80:81]
  v_cndmask_b32 v237, 0, v6, s[82:83]
  v_cndmask_b32 v238, 0, v6, s[84:85]
  v_cndmask_b32 v239, 0, v6, s[86:87]
  s_xor_b32 s45, s17, 65536
  s_movk_i32 s44, 8
L_w20:
  s_getreg_b32 s39, hwreg(HW_REG_IB_STS, 0, 4)
  s_cmp_le_u32 s39, 6
  s_cbranch_scc1 L_b20
  s_sub_u32 s44, s44, 1
  s_cbranch_scc0 L_w20
L_b20:
  s_waitcnt vmcnt(9)
  buffer_load_dwordx4 v[24:27], v3, s[96:99], s45 offen nt
  v_mov_b32 v228, 0
  v_mov_b32 v229, 0
  v_mov_b32 v230, 0
  v_mov_b32 v231, 0
  s_xor_b32 s45, s17, 86016
  s_movk_i32 s44, 8
L_w21:
  s_getreg_b32 s39, hwreg(HW_REG_IB_STS, 0, 4)
  s_cmp_le_u32 s39, 6
  s_cbranch_scc1 L_b21
  s_sub_u32 s44, s44, 1
  s_cbranch_scc0 L_w21
L_b21:
  s_waitcnt vmcnt(9)
  buffer_load_dwordx4 v[28:31], v3, s[96:99], s45 offen nt
  v_mov_b32 v232, 0
  v_mov_b32 v233, 0
  v_mov_b32 v234, 0
  v_mov_b32 v235, 0
  ds_write_b32 v7, v251 offset:80
  s_xor_b32 s45, s17, 106496
  s_movk_i32 s44, 8
L_w22:
  s_getreg_b32 s39, hwreg(HW_REG_IB_STS, 0, 4)
  s_cmp_le_u32 s39, 6
  s_cbranch_scc1 L_b22
  s_sub_u32 s44, s44, 1
  s_cbranch_scc0 L_w22
L_b22:
  s_waitcnt vmcnt(9)
  buffer_load_dwordx4 v[32:35], v3, s[96:99], s45 offen nt
  v_lshlrev_b32 v5, 4, v5
  v_add_u32 v5, 109824, v5
  v_lshl_add_u32 v249, s46, 2, v5
  s_lshl_b32 s37, s46, 10
  s_xor_b32 s45, s17, 126976
  s_movk_i32 s44, 8
L_w23:
  s_getreg_b32 s39, hwreg(HW_REG_IB_STS, 0, 4)
  s_cmp_le_u32 s39, 4
  s_cbranch_scc1 L_b23
  s_sub_u32 s44, s44, 1
  s_cbranch_scc0 L_w23
L_b23:
  s_waitcnt vmcnt(9)
  buffer_load_dwordx4 v[36:39], v3, s[96:99], s45 offen nt
  ds_write_b32 v250, v251 offset:16
  s_add_u32 s37, s37, 109888
  v_add_u32 v6, s37, v2
  s_mov_b32 s56, 1035273459
  s_xor_b32 s45, s17, 131072
  s_movk_i32 s44, 8
L_w24:
  s_getreg_b32 s39, hwreg(HW_REG_IB_STS, 0, 4)
  s_cmp_le_u32 s39, 4
  s_cbranch_scc1 L_b24
  s_sub_u32 s44, s44, 1
  s_cbranch_scc0 L_w24
L_b24:
  s_waitcnt vmcnt(9)
  buffer_load_dwordx4 v[40:43], v3, s[96:99], s45 offen nt
  s_xor_b32 s45, s17, 151552
  s_movk_i32 s44, 8
L_w25:
  s_getreg_b32 s39, hwreg(HW_REG_IB_STS, 0, 4)
  s_cmp_le_u32 s39, 4
  s_cbranch_scc1 L_b25
  s_sub_u32 s44, s44, 1
  s_cbranch_scc0 L_w25
L_b25:
  s_waitcnt vmcnt(9)
  buffer_load_dwordx4 v[44:47], v3, s[96:99], s45 offen nt
  ds_write_b32 v250, v251 offset:96
  s_waitcnt vmcnt(8)
  v_sub_u32 v254, v254, v253
  v_cmp_gt_u32 vcc, 64, v254
  s_bcnt1_i32_b32 s94, vcc_lo
  s_max_u32 s95, s94, 16
  s_sub_u32 s95, s95, 16
  s_mul_i32 s95, s95, s95
  s_mul_i32 s95, s95, 5
  s_lshr_b32 s95, s95, 7
  s_xor_b32 s45, s17, 172032
  s_cmp_gt_i32 s95, 0
  s_cselect_b32 s44, 0, 7
L_w26:
  s_getreg_b32 s39, hwreg(HW_REG_IB_STS, 0, 4)
  s_cmp_le_u32 s39, 4
  s_cbranch_scc1 L_b26
  s_sub_u32 s44, s44, 1
  s_cbranch_scc0 L_w26
L_b26:
  s_waitcnt vmcnt(7)
  buffer_load_dwordx4 v[48:51], v3, s[96:99], s45 offen nt
  s_xor_b32 s45, s17, 192512
  s_cmp_gt_i32 s95, 1
  s_cselect_b32 s44, 0, 8
L_w27:
  s_getreg_b32 s39, hwreg(HW_REG_IB_STS, 0, 4)
  s_cmp_le_u32 s39, 4
  s_cbranch_scc1 L_b27
  s_sub_u32 s44, s44, 1
  s_cbranch_scc0 L_w27
L_b27:
  s_waitcnt vmcnt(7)
  buffer_load_dwordx4 v[52:55], v3, s[96:99], s45 offen nt
  s_add_u32 s94, s58, 1
  v_mov_b32 v253, s94
  s_mov_b64 exec, 1
  buffer_store_dword v253, v252, s[24:27], s101 offen
  s_mov_b64 exec, -1
  buffer_load_dword v254, v252, s[24:27], s100 offen sc1
  s_xor_b32 s45, s17, 196608
  s_cmp_gt_i32 s95, 2
  s_cselect_b32 s44, 0, 8
L_w28:
  s_getreg_b32 s39, hwreg(HW_REG_IB_STS, 0, 4)
  s_cmp_le_u32 s39, 6
  s_cbranch_scc1 L_b28
  s_sub_u32 s44, s44, 1
  s_cbranch_scc0 L_w28
L_b28:
  s_waitcnt vmcnt(9)
  buffer_load_dwordx4 v[56:59], v3, s[96:99], s45 offen nt
  s_xor_b32 s45, s17, 217088
  s_cmp_gt_i32 s95, 3
  s_cselect_b32 s44, 0, 8
L_w29:
  s_getreg_b32 s39, hwreg(HW_REG_IB_STS, 0, 4)
  s_cmp_le_u32 s39, 6
  s_cbranch_scc1 L_b29
  s_sub_u32 s44, s44, 1
  s_cbranch_scc0 L_w29
L_b29:
  s_waitcnt vmcnt(9)
  buffer_load_dwordx4 v[60:63], v3, s[96:99], s45 offen nt
  s_xor_b32 s45, s17, 237568
  s_cmp_gt_i32 s95, 4
  s_cselect_b32 s44, 0, 8
L_w30:
  s_getreg_b32 s39, hwreg(HW_REG_IB_STS, 0, 4)
  s_cmp_le_u32 s39, 6
  s_cbranch_scc1 L_b30
  s_sub_u32 s44, s44, 1
  s_cbranch_scc0 L_w30
L_b30:
  s_waitcnt vmcnt(9)
  buffer_load_dwordx4 v[64:67], v3, s[96:99], s45 offen nt
  s_xor_b32 s45, s17, 258048
  s_cmp_gt_i32 s95, 5
  s_cselect_b32 s44, 0, 8
L_w31:
  s_getreg_b32 s39, hwreg(HW_REG_IB_STS, 0, 4)
  s_cmp_le_u32 s39, 6
  s_cbranch_scc1 L_b31
  s_sub_u32 s44, s44, 1
  s_cbranch_scc0 L_w31
L_b31:
  s_waitcnt vmcnt(9)
  buffer_load_dwordx4 v[68:71], v3, s[96:99], s45 offen nt
  s_xor_b32 s45, s17, 262144
  s_cmp_gt_i32 s95, 6
  s_cselect_b32 s44, 0, 8
L_w32:
  s_getreg_b32 s39, hwreg(HW_REG_IB_STS, 0, 4)
  s_cmp_le_u32 s39, 6
  s_cbranch_scc1 L_b32
  s_sub_u32 s44, s44, 1
  s_cbranch_scc0 L_w32
L_b32:
  s_waitcnt vmcnt(9)
  buffer_load_dwordx4 v[72:75], v3, s[96:99], s45 offen nt
  s_xor_b32 s45, s17, 282624
  s_cmp_gt_i32 s95, 7
  s_cselect_b32 s44, 0, 8
L_w33:
  s_getreg_b32 s39, hwreg(HW_REG_IB_STS, 0, 4)
  s_cmp_le_u32 s39, 4
  s_cbranch_scc1 L_b33
  s_sub_u32 s44, s44, 1
  s_cbranch_scc0 L_w33
L_b33:
  s_waitcnt vmcnt(9)
  buffer_load_dwordx4 v[76:79], v3, s[96:99], s45 offen nt
  s_xor_b32 s45, s17, 303104
  s_cmp_gt_i32 s95, 8
  s_cselect_b32 s44, 0, 8
L_w34:
  s_getreg_b32 s39, hwreg(HW_REG_IB_STS, 0, 4)
  s_cmp_le_u32 s39, 4
  s_cbranch_scc1 L_b34
  s_sub_u32 s44, s44, 1
  s_cbranch_scc0 L_w34
L_b34:
  s_waitcnt vmcnt(9)
  buffer_load_dwordx4 v[80:83], v3, s[96:99], s45 offen nt
  s_xor_b32 s45, s17, 323584
  s_cmp_gt_i32 s95, 9
  s_cselect_b32 s44, 0, 8
L_w35:
  s_getreg_b32 s39, hwreg(HW_REG_IB_STS, 0, 4)
  s_cmp_le_u32 s39, 4
  s_cbranch_scc1 L_b35
  s_sub_u32 s44, s44, 1
  s_cbranch_scc0 L_w35
L_b35:
  s_waitcnt vmcnt(9)
  buffer_load_dwordx4 v[84:87], v3, s[96:99], s45 offen nt
  s_waitcnt vmcnt(8)
  v_sub_u32 v254, v254, v253
  v_cmp_gt_u32 vcc, 64, v254
  s_bcnt1_i32_b32 s94, vcc_lo
  s_max_u32 s95, s94, 16
  s_sub_u32 s95, s95, 16
  s_mul_i32 s95, s95, s95
  s_mul_i32 s95, s95, 5
  s_lshr_b32 s95, s95, 7
  s_xor_b32 s45, s17, 327680
  s_cmp_gt_i32 s95, 0
  s_cselect_b32 s44, 0, 7
L_w36:
  s_getreg_b32 s39, hwreg(HW_REG_IB_STS, 0, 4)
  s_cmp_le_u32 s39, 4
  s_cbranch_scc1 L_b36
  s_sub_u32 s44, s44, 1
  s_cbranch_scc0 L_w36
L_b36:
  s_waitcnt vmcnt(7)
  buffer_load_dwordx4 v[88:91], v3, s[96:99], s45 offen nt
  s_xor_b32 s45, s17, 348160
  s_cmp_gt_i32 s95, 1
  s_cselect_b32 s44, 0, 8
L_w37:
  s_getreg_b32 s39, hwreg(HW_REG_IB_STS, 0, 4)
  s_cmp_le_u32 s39, 4
  s_cbranch_scc1 L_b37
  s_sub_u32 s44, s44, 1
  s_cbranch_scc0 L_w37
L_b37:
  s_waitcnt vmcnt(7)
  buffer_load_dwordx4 v[92:95], v3, s[96:99], s45 offen nt
  s_add_u32 s94, s58, 2
  v_mov_b32 v253, s94
  s_mov_b64 exec, 1
  buffer_store_dword v253, v252, s[24:27], s101 offen
  s_mov_b64 exec, -1
  buffer_load_dword v254, v252, s[24:27], s100 offen sc1
  s_xor_b32 s45, s17, 368640
  s_cmp_gt_i32 s95, 2
  s_cselect_b32 s44, 0, 8
L_w38:
  s_getreg_b32 s39, hwreg(HW_REG_IB_STS, 0, 4)
  s_cmp_le_u32 s39, 6
  s_cbranch_scc1 L_b38
  s_sub_u32 s44, s44, 1
  s_cbranch_scc0 L_w38
L_b38:
  s_waitcnt vmcnt(9)
  buffer_load_dwordx4 v[96:99], v3, s[96:99], s45 offen nt
  s_xor_b32 s45, s17, 389120
  s_cmp_gt_i32 s95, 3
  s_cselect_b32 s44, 0, 8
L_w39:
  s_getreg_b32 s39, hwreg(HW_REG_IB_STS, 0, 4)
  s_cmp_le_u32 s39, 6
  s_cbranch_scc1 L_b39
  s_sub_u32 s44, s44, 1
  s_cbranch_scc0 L_w39
L_b39:
  s_waitcnt vmcnt(9)
  buffer_load_dwordx4 v[100:103], v3, s[96:99], s45 offen nt
  s_xor_b32 s45, s17, 393216
  s_cmp_gt_i32 s95, 4
  s_cselect_b32 s44, 0, 8
L_w40:
  s_getreg_b32 s39, hwreg(HW_REG_IB_STS, 0, 4)
  s_cmp_le_u32 s39, 6
  s_cbranch_scc1 L_b40
  s_sub_u32 s44, s44, 1
  s_cbranch_scc0 L_w40
L_b40:
  s_waitcnt vmcnt(9)
  buffer_load_dwordx4 v[104:107], v3, s[96:99], s45 offen nt
  ds_write_b32 v7, v251 offset:84
  s_xor_b32 s45, s17, 413696
  s_cmp_gt_i32 s95, 5
  s_cselect_b32 s44, 0, 8
L_w41:
  s_getreg_b32 s39, hwreg(HW_REG_IB_STS, 0, 4)
  s_cmp_le_u32 s39, 6
  s_cbranch_scc1 L_b41
  s_sub_u32 s44, s44, 1
  s_cbranch_scc0 L_w41
L_b41:
  s_waitcnt vmcnt(9)
  buffer_load_dwordx4 v[108:111], v3, s[96:99], s45 offen nt
  s_xor_b32 s45, s17, 434176
  s_cmp_gt_i32 s95, 6
  s_cselect_b32 s44, 0, 8
L_w42:
  s_getreg_b32 s39, hwreg(HW_REG_IB_STS, 0, 4)
  s_cmp_le_u32 s39, 6
  s_cbranch_scc1 L_b42
  s_sub_u32 s44, s44, 1
  s_cbranch_scc0 L_w42
L_b42:
  s_waitcnt vmcnt(9)
  buffer_load_dwordx4 v[112:115], v3, s[96:99], s45 offen nt
  s_xor_b32 s45, s17, 454656
  s_cmp_gt_i32 s95, 7
  s_cselect_b32 s44, 0, 8
L_w43:
  s_getreg_b32 s39, hwreg(HW_REG_IB_STS, 0, 4)
  s_cmp_le_u32 s39, 4
  s_cbranch_scc1 L_b43
  s_sub_u32 s44, s44, 1
  s_cbranch_scc0 L_w43
L_b43:
  s_waitcnt vmcnt(9)
  buffer_load_dwordx4 v[116:119], v3, s[96:99], s45 offen nt
  s_xor_b32 s45, s17, 458752
  s_cmp_gt_i32 s95, 8
  s_cselect_b32 s44, 0, 8
L_w44:
  s_getreg_b32 s39, hwreg(HW_REG_IB_STS, 0, 4)
  s_cmp_le_u32 s39, 4
  s_cbranch_scc1 L_b44
  s_sub_u32 s44, s44, 1
  s_cbranch_scc0 L_w44
L_b44:
  s_waitcnt vmcnt(9)
  buffer_load_dwordx4 v[120:123], v3, s[96:99], s45 offen nt
  s_xor_b32 s45, s17, 479232
  s_cmp_gt_i32 s95, 9
  s_cselect_b32 s44, 0, 8
L_w45:
  s_getreg_b32 s39, hwreg(HW_REG_IB_STS, 0, 4)
  s_cmp_le_u32 s39, 4
  s_cbranch_scc1 L_b45
  s_sub_u32 s44, s44, 1
  s_cbranch_scc0 L_w45
L_b45:
  s_waitcnt vmcnt(9)
  buffer_load_dwordx4 v[124:127], v3, s[96:99], s45 offen nt
  s_waitcnt vmcnt(8)
  v_sub_u32 v254, v254, v253
  v_cmp_gt_u32 vcc, 64, v254
  s_bcnt1_i32_b32 s94, vcc_lo
  s_max_u32 s95, s94, 16
  s_sub_u32 s95, s95, 16
  s_mul_i32 s95, s95, s95
  s_mul_i32 s95, s95, 5
  s_lshr_b32 s95, s95, 7
  s_xor_b32 s45, s17, 499712
  s_cmp_gt_i32 s95, 0
  s_cselect_b32 s44, 0, 7
L_w46:
  s_getreg_b32 s39, hwreg(HW_REG_IB_STS, 0, 4)
  s_cmp_le_u32 s39, 4
  s_cbranch_scc1 L_b46
  s_sub_u32 s44, s44, 1
  s_cbranch_scc0 L_w46
L_b46:
  s_waitcnt vmcnt(7)
  buffer_load_dwordx4 v[128:131], v3, s[96:99], s45 offen nt
  s_xor_b32 s45, s17, 520192
  s_cmp_gt_i32 s95, 1
  s_cselect_b32 s44, 0, 8
L_w47:
  s_getreg_b32 s39, hwreg(HW_REG_IB_STS, 0, 4)
  s_cmp_le_u32 s39, 4
  s_cbranch_scc1 L_b47
  s_sub_u32 s44, s44, 1
  s_cbranch_scc0 L_w47
L_b47:
  s_waitcnt vmcnt(7)
  buffer_load_dwordx4 v[132:135], v3, s[96:99], s45 offen nt
  s_add_u32 s94, s58, 3
  v_mov_b32 v253, s94
  s_mov_b64 exec, 1
  buffer_store_dword v253, v252, s[24:27], s101 offen
  s_mov_b64 exec, -1
  buffer_load_dword v254, v252, s[24:27], s100 offen sc1
L_kvq:
  ds_read_b32 v1, v7 offset:32
  s_add_u32 s59, s59, 1
  s_cmp_gt_u32 s59, 200000
  s_cbranch_scc1 L_exit
  s_waitcnt lgkmcnt(0)
  v_cmp_ne_u32 vcc, 0, v1
  s_cbranch_vccnz L_kvq_ok
  s_sleep 1
  s_branch L_kvq
L_kvq_ok:
  s_mov_b32 exec_lo, 0x0f0f0f0f
  s_mov_b32 exec_hi, 0x0f0f0f0f
  ds_read_b128 v[228:231], v4
  s_not_b64 exec, exec
  ds_read_b128 v[232:235], v4
  s_mov_b64 exec, -1
  s_xor_b32 s45, s17, 40960
  s_cmp_gt_i32 s95, 2
  s_cselect_b32 s44, 0, 5
L_w48:
  s_getreg_b32 s39, hwreg(HW_REG_IB_STS, 0, 4)
  s_cmp_le_u32 s39, 6
  s_cbranch_scc1 L_b48
  s_sub_u32 s44, s44, 1
  s_cbranch_scc0 L_w48
L_b48:
  s_waitcnt vmcnt(9)
  buffer_load_dwordx4 v[144:147], v2, s[8:11], s45 offen nt
  s_waitcnt lgkmcnt(0)
  v_mfma_f32_16x16x32_bf16 v[8:11], v[8:11], v[228:231], 0
  v_mfma_f32_16x16x32_bf16 v[16:19], v[16:19], v[228:231], 0
  v_mfma_f32_16x16x32_bf16 v[24:27], v[24:27], v[228:231], 0
  v_mfma_f32_16x16x32_bf16 v[32:35], v[32:35], v[228:231], 0
  v_mfma_f32_16x16x32_bf16 v[8:11], v[12:15], v[232:235], v[8:11]
  v_mfma_f32_16x16x32_bf16 v[16:19], v[20:23], v[232:235], v[16:19]
  v_mfma_f32_16x16x32_bf16 v[24:27], v[28:31], v[232:235], v[24:27]
  v_mfma_f32_16x16x32_bf16 v[32:35], v[36:39], v[232:235], v[32:35]
  v_mfma_f32_16x16x32_bf16 v[40:43], v[40:43], v[228:231], 0
  v_mfma_f32_16x16x32_bf16 v[48:51], v[48:51], v[228:231], 0
  v_mfma_f32_16x16x32_bf16 v[56:59], v[56:59], v[228:231], 0
  v_mfma_f32_16x16x32_bf16 v[64:67], v[64:67], v[228:231], 0
  v_mfma_f32_16x16x32_bf16 v[40:43], v[44:47], v[232:235], v[40:43]
  s_xor_b32 s45, s17, 61440
  s_cmp_gt_i32 s95, 3
  s_cselect_b32 s44, 0, 3
L_w49:
  s_getreg_b32 s39, hwreg(HW_REG_IB_STS, 0, 4)
  s_cmp_le_u32 s39, 6
  s_cbranch_scc1 L_b49
  s_sub_u32 s44, s44, 1
  s_cbranch_scc0 L_w49
L_b49:
  s_waitcnt vmcnt(9)
  buffer_load_dwordx4 v[148:151], v2, s[8:11], s45 offen nt
  v_mfma_f32_16x16x32_bf16 v[48:51], v[52:55], v[232:235], v[48:51]
  v_mfma_f32_16x16x32_bf16 v[56:59], v[60:63], v[232:235], v[56:59]
  v_mfma_f32_16x16x32_bf16 v[64:67], v[68:71], v[232:235], v[64:67]
  v_mov_b32_dpp v8, v8 quad_perm:[0,0,0,0] row_mask:0xf bank_mask:0xf
  v_mov_b32_dpp v16, v16 quad_perm:[0,0,0,0] row_mask:0xf bank_mask:0xf
  v_mov_b32_dpp v24, v24 quad_perm:[0,0,0,0] row_mask:0xf bank_mask:0xf
  v_mov_b32_dpp v32, v32 quad_perm:[0,0,0,0] row_mask:0xf bank_mask:0xf
  v_add_f32_dpp v8, v9, v8 quad_perm:[1,1,1,1] row_mask:0xf bank_mask:0xf
  v_add_f32_dpp v16, v17, v16 quad_perm:[1,1,1,1] row_mask:0xf bank_mask:0xf
  v_add_f32_dpp v24, v25, v24 quad_perm:[1,1,1,1] row_mask:0xf bank_mask:0xf
  v_add_f32_dpp v32, v33, v32 quad_perm:[1,1,1,1] row_mask:0xf bank_mask:0xf
  v_add_f32_dpp v8, v10, v8 quad_perm:[2,2,2,2] row_mask:0xf bank_mask:0xf
  v_add_f32_dpp v16, v18, v16 quad_perm:[2,2,2,2] row_mask:0xf bank_mask:0xf
  v_add_f32_dpp v24, v26, v24 quad_perm:[2,2,2,2] row_mask:0xf bank_mask:0xf
  v_add_f32_dpp v32, v34, v32 quad_perm:[2,2,2,2] row_mask:0xf bank_mask:0xf
  v_add_f32_dpp v8, v11, v8 quad_perm:[3,3,3,3] row_mask:0xf bank_mask:0xf
  v_add_f32_dpp v16, v19, v16 quad_perm:[3,3,3,3] row_mask:0xf bank_mask:0xf
  v_add_f32_dpp v24, v27, v24 quad_perm:[3,3,3,3] row_mask:0xf bank_mask:0xf
  v_add_f32_dpp v32, v35, v32 quad_perm:[3,3,3,3] row_mask:0xf bank_mask:0xf
  v_cvt_pk_bf16_f32 v8, 0, v8
  v_cvt_pk_bf16_f32 v16, 0, v16
  v_cvt_pk_bf16_f32 v24, 0, v24
  v_cvt_pk_bf16_f32 v32, 0, v32
  v_mul_f32 v8, s56, v8
  v_mul_f32 v16, s56, v16
  v_mul_f32 v24, s56, v24
  v_mul_f32 v32, s56, v32
  v_cvt_pk_bf16_f32 v8, 0, v8
  v_cvt_pk_bf16_f32 v16, 0, v16
  v_cvt_pk_bf16_f32 v24, 0, v24
  v_cvt_pk_bf16_f32 v32, 0, v32
  v_max_f32 v244, v8, v16
  v_max3_f32 v244, v24, v32, v244
  v_mfma_f32_16x16x32_bf16 v[72:75], v[72:75], v[228:231], 0
  v_mfma_f32_16x16x32_bf16 v[80:83], v[80:83], v[228:231], 0
  v_mfma_f32_16x16x32_bf16 v[88:91], v[88:91], v[228:231], 0
  s_xor_b32 s45, s17, 65536
  s_cmp_gt_i32 s95, 4
  s_cselect_b32 s44, 0, 4
L_w50:
  s_getreg_b32 s39, hwreg(HW_REG_IB_STS, 0, 4)
  s_cmp_le_u32 s39, 6
  s_cbranch_scc1 L_b50
  s_sub_u32 s44, s44, 1
  s_cbranch_scc0 L_w50
L_b50:
  s_waitcnt vmcnt(9)
  buffer_load_dwordx4 v[152:155], v2, s[8:11], s45 offen nt
  v_mfma_f32_16x16x32_bf16 v[96:99], v[96:99], v[228:231], 0
  v_mfma_f32_16x16x32_bf16 v[72:75], v[76:79], v[232:235], v[72:75]
  v_mfma_f32_16x16x32_bf16 v[80:83], v[84:87], v[232:235], v[80:83]
  v_mfma_f32_16x16x32_bf16 v[88:91], v[92:95], v[232:235], v[88:91]
  v_mfma_f32_16x16x32_bf16 v[96:99], v[100:103], v[232:235], v[96:99]
  v_mov_b32_dpp v40, v40 quad_perm:[0,0,0,0] row_mask:0xf bank_mask:0xf
  v_mov_b32_dpp v48, v48 quad_perm:[0,0,0,0] row_mask:0xf bank_mask:0xf
  v_mov_b32_dpp v56, v56 quad_perm:[0,0,0,0] row_mask:0xf bank_mask:0xf
  v_mov_b32_dpp v64, v64 quad_perm:[0,0,0,0] row_mask:0xf bank_mask:0xf
  v_add_f32_dpp v40, v41, v40 quad_perm:[1,1,1,1] row_mask:0xf bank_mask:0xf
  v_add_f32_dpp v48, v49, v48 quad_perm:[1,1,1,1] row_mask:0xf bank_mask:0xf
  v_add_f32_dpp v56, v57, v56 quad_perm:[1,1,1,1] row_mask:0xf bank_mask:0xf
  v_add_f32_dpp v64, v65, v64 quad_perm:[1,1,1,1] row_mask:0xf bank_mask:0xf
  v_add_f32_dpp v40, v42, v40 quad_perm:[2,2,2,2] row_mask:0xf bank_mask:0xf
  v_add_f32_dpp v48, v50, v48 quad_perm:[2,2,2,2] row_mask:0xf bank_mask:0xf
  v_add_f32_dpp v56, v58, v56 quad_perm:[2,2,2,2] row_mask:0xf bank_mask:0xf
  v_add_f32_dpp v64, v66, v64 quad_perm:[2,2,2,2] row_mask:0xf bank_mask:0xf
  v_add_f32_dpp v40, v43, v40 quad_perm:[3,3,3,3] row_mask:0xf bank_mask:0xf
  v_add_f32_dpp v48, v51, v48 quad_perm:[3,3,3,3] row_mask:0xf bank_mask:0xf
  v_add_f32_dpp v56, v59, v56 quad_perm:[3,3,3,3] row_mask:0xf bank_mask:0xf
  v_add_f32_dpp v64, v67, v64 quad_perm:[3,3,3,3] row_mask:0xf bank_mask:0xf
  v_cvt_pk_bf16_f32 v40, 0, v40
  v_cvt_pk_bf16_f32 v48, 0, v48
  v_cvt_pk_bf16_f32 v56, 0, v56
  v_cvt_pk_bf16_f32 v64, 0, v64
  v_mul_f32 v40, s56, v40
  v_mul_f32 v48, s56, v48
  v_mul_f32 v56, s56, v56
  v_mul_f32 v64, s56, v64
  v_cvt_pk_bf16_f32 v40, 0, v40
  v_cvt_pk_bf16_f32 v48, 0, v48
  v_cvt_pk_bf16_f32 v56, 0, v56
  v_cvt_pk_bf16_f32 v64, 0, v64
  v_max3_f32 v244, v40, v48, v244
  v_max3_f32 v244, v56, v64, v244
  v_mov_b32_dpp v72, v72 quad_perm:[0,0,0,0] row_mask:0xf bank_mask:0xf
  v_mov_b32_dpp v80, v80 quad_perm:[0,0,0,0] row_mask:0xf bank_mask:0xf
  s_xor_b32 s45, s17, 86016
  s_cmp_gt_i32 s95, 5
  s_cselect_b32 s44, 0, 4
L_w51:
  s_getreg_b32 s39, hwreg(HW_REG_IB_STS, 0, 4)
  s_cmp_le_u32 s39, 6
  s_cbranch_scc1 L_b51
  s_sub_u32 s44, s44, 1
  s_cbranch_scc0 L_w51
L_b51:
  s_waitcnt vmcnt(9)
  buffer_load_dwordx4 v[156:159], v2, s[8:11], s45 offen nt
  v_mov_b32_dpp v88, v88 quad_perm:[0,0,0,0] row_mask:0xf bank_mask:0xf
  v_mov_b32_dpp v96, v96 quad_perm:[0,0,0,0] row_mask:0xf bank_mask:0xf
  v_add_f32_dpp v72, v73, v72 quad_perm:[1,1,1,1] row_mask:0xf bank_mask:0xf
  v_add_f32_dpp v80, v81, v80 quad_perm:[1,1,1,1] row_mask:0xf bank_mask:0xf
  v_add_f32_dpp v88, v89, v88 quad_perm:[1,1,1,1] row_mask:0xf bank_mask:0xf
  v_add_f32_dpp v96, v97, v96 quad_perm:[1,1,1,1] row_mask:0xf bank_mask:0xf
  v_add_f32_dpp v72, v74, v72 quad_perm:[2,2,2,2] row_mask:0xf bank_mask:0xf
  v_add_f32_dpp v80, v82, v80 quad_perm:[2,2,2,2] row_mask:0xf bank_mask:0xf
  v_add_f32_dpp v88, v90, v88 quad_perm:[2,2,2,2] row_mask:0xf bank_mask:0xf
  v_add_f32_dpp v96, v98, v96 quad_perm:[2,2,2,2] row_mask:0xf bank_mask:0xf
  v_add_f32_dpp v72, v75, v72 quad_perm:[3,3,3,3] row_mask:0xf bank_mask:0xf
  v_add_f32_dpp v80, v83, v80 quad_perm:[3,3,3,3] row_mask:0xf bank_mask:0xf
  v_add_f32_dpp v88, v91, v88 quad_perm:[3,3,3,3] row_mask:0xf bank_mask:0xf
  v_add_f32_dpp v96, v99, v96 quad_perm:[3,3,3,3] row_mask:0xf bank_mask:0xf
  v_cvt_pk_bf16_f32 v72, 0, v72
  v_cvt_pk_bf16_f32 v80, 0, v80
  v_cvt_pk_bf16_f32 v88, 0, v88
  v_cvt_pk_bf16_f32 v96, 0, v96
  v_mul_f32 v72, s56, v72
  v_mul_f32 v80, s56, v80
  v_mul_f32 v88, s56, v88
  v_mul_f32 v96, s56, v96
  v_cvt_pk_bf16_f32 v72, 0, v72
  v_cvt_pk_bf16_f32 v80, 0, v80
  v_cvt_pk_bf16_f32 v88, 0, v88
  v_cvt_pk_bf16_f32 v96, 0, v96
  v_max3_f32 v244, v72, v80, v244
  v_max3_f32 v244, v88, v96, v244
  s_xor_b32 s45, s17, 106496
  s_cmp_gt_i32 s95, 6
  s_cselect_b32 s44, 0, 6
L_w52:
  s_getreg_b32 s39, hwreg(HW_REG_IB_STS, 0, 4)
  s_cmp_le_u32 s39, 6
  s_cbranch_scc1 L_b52
  s_sub_u32 s44, s44, 1
  s_cbranch_scc0 L_w52
L_b52:
  s_waitcnt vmcnt(9)
  buffer_load_dwordx4 v[160:163], v2, s[8:11], s45 offen nt
  s_xor_b32 s45, s17, 126976
  s_cmp_gt_i32 s95, 7
  s_cselect_b32 s44, 0, 8
L_w53:
  s_getreg_b32 s39, hwreg(HW_REG_IB_STS, 0, 4)
  s_cmp_le_u32 s39, 4
  s_cbranch_scc1 L_b53
  s_sub_u32 s44, s44, 1
  s_cbranch_scc0 L_w53
L_b53:
  s_waitcnt vmcnt(9)
  buffer_load_dwordx4 v[164:167], v2, s[8:11], s45 offen nt
  s_xor_b32 s45, s17, 131072
  s_cmp_gt_i32 s95, 8
  s_cselect_b32 s44, 0, 8
L_w54:
  s_getreg_b32 s39, hwreg(HW_REG_IB_STS, 0, 4)
  s_cmp_le_u32 s39, 4
  s_cbranch_scc1 L_b54
  s_sub_u32 s44, s44, 1
  s_cbranch_scc0 L_w54
L_b54:
  s_waitcnt vmcnt(9)
  buffer_load_dwordx4 v[168:171], v2, s[8:11], s45 offen nt
  s_xor_b32 s45, s17, 151552
  s_cmp_gt_i32 s95, 9
  s_cselect_b32 s44, 0, 8
L_w55:
  s_getreg_b32 s39, hwreg(HW_REG_IB_STS, 0, 4)
  s_cmp_le_u32 s39, 4
  s_cbranch_scc1 L_b55
  s_sub_u32 s44, s44, 1
  s_cbranch_scc0 L_w55
L_b55:
  s_waitcnt vmcnt(9)
  buffer_load_dwordx4 v[172:175], v2, s[8:11], s45 offen nt
  s_waitcnt vmcnt(8)
  v_sub_u32 v254, v254, v253
  v_cmp_gt_u32 vcc, 64, v254
  s_bcnt1_i32_b32 s94, vcc_lo
  s_max_u32 s95, s94, 16
  s_sub_u32 s95, s95, 16
  s_mul_i32 s95, s95, s95
  s_mul_i32 s95, s95, 5
  s_lshr_b32 s95, s95, 7
  s_xor_b32 s45, s17, 172032
  s_cmp_gt_i32 s95, 0
  s_cselect_b32 s44, 0, 7
L_w56:
  s_getreg_b32 s39, hwreg(HW_REG_IB_STS, 0, 4)
  s_cmp_le_u32 s39, 4
  s_cbranch_scc1 L_b56
  s_sub_u32 s44, s44, 1
  s_cbranch_scc0 L_w56
L_b56:
  s_waitcnt vmcnt(7)
  buffer_load_dwordx4 v[176:179], v2, s[8:11], s45 offen nt
  v_mfma_f32_16x16x32_bf16 v[104:107], v[104:107], v[228:231], 0
  v_mfma_f32_16x16x32_bf16 v[112:115], v[112:115], v[228:231], 0
  v_mfma_f32_16x16x32_bf16 v[120:123], v[120:123], v[228:231], 0
  v_mfma_f32_16x16x32_bf16 v[128:131], v[128:131], v[228:231], 0
  v_mfma_f32_16x16x32_bf16 v[104:107], v[108:111], v[232:235], v[104:107]
  v_mfma_f32_16x16x32_bf16 v[112:115], v[116:119], v[232:235], v[112:115]
  v_mfma_f32_16x16x32_bf16 v[120:123], v[124:127], v[232:235], v[120:123]
  v_mfma_f32_16x16x32_bf16 v[128:131], v[132:135], v[232:235], v[128:131]
  s_nop 4
  v_mov_b32_dpp v104, v104 quad_perm:[0,0,0,0] row_mask:0xf bank_mask:0xf
  v_mov_b32_dpp v112, v112 quad_perm:[0,0,0,0] row_mask:0xf bank_mask:0xf
  v_mov_b32_dpp v120, v120 quad_perm:[0,0,0,0] row_mask:0xf bank_mask:0xf
  v_mov_b32_dpp v128, v128 quad_perm:[0,0,0,0] row_mask:0xf bank_mask:0xf
  v_add_f32_dpp v104, v105, v104 quad_perm:[1,1,1,1] row_mask:0xf bank_mask:0xf
  v_add_f32_dpp v112, v113, v112 quad_perm:[1,1,1,1] row_mask:0xf bank_mask:0xf
  v_add_f32_dpp v120, v121, v120 quad_perm:[1,1,1,1] row_mask:0xf bank_mask:0xf
  v_add_f32_dpp v128, v129, v128 quad_perm:[1,1,1,1] row_mask:0xf bank_mask:0xf
  v_add_f32_dpp v104, v106, v104 quad_perm:[2,2,2,2] row_mask:0xf bank_mask:0xf
  v_add_f32_dpp v112, v114, v112 quad_perm:[2,2,2,2] row_mask:0xf bank_mask:0xf
  v_add_f32_dpp v120, v122, v120 quad_perm:[2,2,2,2] row_mask:0xf bank_mask:0xf
  v_add_f32_dpp v128, v130, v128 quad_perm:[2,2,2,2] row_mask:0xf bank_mask:0xf
  v_add_f32_dpp v104, v107, v104 quad_perm:[3,3,3,3] row_mask:0xf bank_mask:0xf
  v_add_f32_dpp v112, v115, v112 quad_perm:[3,3,3,3] row_mask:0xf bank_mask:0xf
  v_add_f32_dpp v120, v123, v120 quad_perm:[3,3,3,3] row_mask:0xf bank_mask:0xf
  v_add_f32_dpp v128, v131, v128 quad_perm:[3,3,3,3] row_mask:0xf bank_mask:0xf
  v_cvt_pk_bf16_f32 v104, 0, v104
  v_cvt_pk_bf16_f32 v112, 0, v112
  v_cvt_pk_bf16_f32 v120, 0, v120
  v_cvt_pk_bf16_f32 v128, 0, v128
  s_xor_b32 s45, s17, 192512
  s_cmp_gt_i32 s95, 1
  s_cselect_b32 s44, 0, 4
L_w57:
  s_getreg_b32 s39, hwreg(HW_REG_IB_STS, 0, 4)
  s_cmp_le_u32 s39, 4
  s_cbranch_scc1 L_b57
  s_sub_u32 s44, s44, 1
  s_cbranch_scc0 L_w57
L_b57:
  s_waitcnt vmcnt(7)
  buffer_load_dwordx4 v[180:183], v2, s[8:11], s45 offen nt
  v_mul_f32 v104, s56, v104
  v_mul_f32 v112, s56, v112
  v_mul_f32 v120, s56, v120
  v_mul_f32 v128, s56, v128
  v_cvt_pk_bf16_f32 v104, 0, v104
  v_cvt_pk_bf16_f32 v112, 0, v112
  v_cvt_pk_bf16_f32 v120, 0, v120
  v_cvt_pk_bf16_f32 v128, 0, v128
  v_max3_f32 v244, v104, v112, v244
  v_max3_f32 v244, v120, v128, v244
  s_nop 1
  v_max_f32_dpp v244, v244, v244 row_half_mirror row_mask:0xf bank_mask:0xf
  v_mov_b32 v246, v244
  s_nop 1
  v_permlane16_swap_b32 v244, v246
  v_max_f32 v244, v244, v246
  v_mov_b32 v246, v244
  s_nop 1
  v_permlane32_swap_b32 v244, v246
  v_max_f32 v244, v244, v246
  v_or_b32 v244, 1, v244
  ds_write_b32 v249, v244
  s_xor_b32 s45, s17, 196608
  s_cmp_gt_i32 s95, 2
  s_cselect_b32 s44, 0, 7
L_w58:
  s_getreg_b32 s39, hwreg(HW_REG_IB_STS, 0, 4)
  s_cmp_le_u32 s39, 4
  s_cbranch_scc1 L_b58
  s_sub_u32 s44, s44, 1
  s_cbranch_scc0 L_w58
L_b58:
  s_waitcnt vmcnt(7)
  buffer_load_dwordx4 v[184:187], v2, s[8:11], s45 offen nt
  s_xor_b32 s45, s17, 217088
  s_cmp_gt_i32 s95, 3
  s_cselect_b32 s44, 0, 8
L_w59:
  s_getreg_b32 s39, hwreg(HW_REG_IB_STS, 0, 4)
  s_cmp_le_u32 s39, 4
  s_cbranch_scc1 L_b59
  s_sub_u32 s44, s44, 1
  s_cbranch_scc0 L_w59
L_b59:
  s_waitcnt vmcnt(7)
  buffer_load_dwordx4 v[188:191], v2, s[8:11], s45 offen nt
  s_xor_b32 s45, s17, 237568
  s_cmp_gt_i32 s95, 4
  s_cselect_b32 s44, 0, 8
L_w60:
  s_getreg_b32 s39, hwreg(HW_REG_IB_STS, 0, 4)
  s_cmp_le_u32 s39, 4
  s_cbranch_scc1 L_b60
  s_sub_u32 s44, s44, 1
  s_cbranch_scc0 L_w60
L_b60:
  s_waitcnt vmcnt(7)
  buffer_load_dwordx4 v[192:195], v2, s[8:11], s45 offen nt
  s_add_u32 s94, s58, 4
  v_mov_b32 v253, s94
  s_mov_b64 exec, 1
  buffer_store_dword v253, v252, s[24:27], s101 offen
  s_mov_b64 exec, -1
  buffer_load_dword v254, v252, s[24:27], s100 offen sc1
L_mx:
  ds_read_b128 v[228:231], v5
  s_add_u32 s59, s59, 1
  s_cmp_gt_u32 s59, 200000
  s_cbranch_scc1 L_exit
  s_waitcnt lgkmcnt(0)
  v_and_b32 v246, v228, v229
  v_and_b32 v247, v230, v231
  v_and_b32 v246, v246, v247
  v_and_b32 v246, 1, v246
  v_cmp_eq_u32 vcc, 0, v246
  s_cbranch_vccnz L_mx
  v_max3_f32 v244, v228, v229, v230
  v_max_f32 v244, v244, v231
  v_and_b32 v244, -2, v244
  v_mul_f32 v244, s57, v244
  v_fma_f32 v8, v8, s57, -v244
  v_fma_f32 v16, v16, s57, -v244
  v_fma_f32 v24, v24, s57, -v244
  v_fma_f32 v32, v32, s57, -v244
  v_exp_f32 v8, v8
  v_exp_f32 v16, v16
  v_exp_f32 v24, v24
  v_exp_f32 v32, v32
  v_add_f32 v245, v8, v16
  v_add_f32 v247, v24, v32
  v_cvt_pk_bf16_f32 v8, v8, v8
  v_cvt_pk_bf16_f32 v16, v16, v16
  v_cvt_pk_bf16_f32 v24, v24, v24
  v_cvt_pk_bf16_f32 v32, v32, v32
  v_fma_f32 v40, v40, s57, -v244
  v_fma_f32 v48, v48, s57, -v244
  v_fma_f32 v56, v56, s57, -v244
  v_fma_f32 v64, v64, s57, -v244
  v_exp_f32 v40, v40
  v_exp_f32 v48, v48
  v_exp_f32 v56, v56
  v_exp_f32 v64, v64
  v_add_f32 v245, v40, v245
  v_add_f32 v247, v48, v247
  v_add_f32 v245, v56, v245
  v_add_f32 v247, v64, v247
  v_cvt_pk_bf16_f32 v40, v40, v40
  v_cvt_pk_bf16_f32 v48, v48, v48
  v_cvt_pk_bf16_f32 v56, v56, v56
  v_cvt_pk_bf16_f32 v64, v64, v64
  v_fma_f32 v72, v72, s57, -v244
  v_fma_f32 v80, v80, s57, -v244
  v_fma_f32 v88, v88, s57, -v244
  v_fma_f32 v96, v96, s57, -v244
  v_exp_f32 v72, v72
  v_exp_f32 v80, v80
  v_exp_f32 v88, v88
  s_xor_b32 s45, s17, 258048
  s_cmp_gt_i32 s95, 5
  s_cselect_b32 s44, 0, 1
L_w61:
  s_getreg_b32 s39, hwreg(HW_REG_IB_STS, 0, 4)
  s_cmp_le_u32 s39, 6
  s_cbranch_scc1 L_b61
  s_sub_u32 s44, s44, 1
  s_cbranch_scc0 L_w61
L_b61:
  s_waitcnt vmcnt(9)
  buffer_load_dwordx4 v[196:199], v2, s[8:11], s45 offen nt
  v_exp_f32 v96, v96
  v_add_f32 v245, v72, v245
  v_add_f32 v247, v80, v247
  v_add_f32 v245, v88, v245
  v_add_f32 v247, v96, v247
  v_cvt_pk_bf16_f32 v72, v72, v72
  v_cvt_pk_bf16_f32 v80, v80, v80
  v_cvt_pk_bf16_f32 v88, v88, v88
  v_cvt_pk_bf16_f32 v96, v96, v96
  v_fma_f32 v104, v104, s57, -v244
  v_fma_f32 v112, v112, s57, -v244
  v_fma_f32 v120, v120, s57, -v244
  v_fma_f32 v128, v128, s57, -v244
  v_exp_f32 v104, v104
  v_exp_f32 v112, v112
  v_exp_f32 v120, v120
  v_exp_f32 v128, v128
  v_add_f32 v245, v104, v245
  v_add_f32 v247, v112, v247
  v_add_f32 v245, v120, v245
  v_add_f32 v247, v128, v247
  v_cvt_pk_bf16_f32 v104, v104, v104
  v_cvt_pk_bf16_f32 v112, v112, v112
  v_cvt_pk_bf16_f32 v120, v120, v120
  v_cvt_pk_bf16_f32 v128, v128, v128
  v_add_f32 v245, v245, v247
  s_nop 1
  v_add_f32_dpp v245, v245, v245 row_half_mirror row_mask:0xf bank_mask:0xf
  v_mov_b32 v246, v245
  s_nop 1
  v_permlane16_swap_b32 v245, v246
  v_add_f32 v245, v245, v246
  v_mov_b32 v246, v245
  s_nop 1
  v_permlane32_swap_b32 v245, v246
  v_add_f32 v245, v245, v246
  v_or_b32 v245, 1, v245
  ds_write_b32 v249, v245 offset:32
  v_and_b32_dpp v12, v8, v236 row_ror:12 row_mask:0xf bank_mask:0xf
  v_and_b32_dpp v13, v8, v237 row_ror:12 row_mask:0xf bank_mask:0xf
  v_and_b32 v14, v8, v238
  v_and_b32 v15, v8, v239
  v_and_b32_dpp v10, v8, v238 row_ror:4 row_mask:0xf bank_mask:0xf
  v_and_b32_dpp v11, v8, v239 row_ror:4 row_mask:0xf bank_mask:0xf
  v_and_b32 v9, v8, v237
  v_and_b32 v8, v8, v236
  v_and_b32_dpp v20, v16, v236 row_ror:12 row_mask:0xf bank_mask:0xf
  v_and_b32_dpp v21, v16, v237 row_ror:12 row_mask:0xf bank_mask:0xf
  v_and_b32 v22, v16, v238
  v_and_b32 v23, v16, v239
  s_xor_b32 s45, s17, 262144
  s_cmp_gt_i32 s95, 6
  s_cselect_b32 s44, 0, 4
L_w62:
  s_getreg_b32 s39, hwreg(HW_REG_IB_STS, 0, 4)
  s_cmp_le_u32 s39, 6
  s_cbranch_scc1 L_b62
  s_sub_u32 s44, s44, 1
  s_cbranch_scc0 L_w62
L_b62:
  s_waitcnt vmcnt(9)
  buffer_load_dwordx4 v[200:203], v2, s[8:11], s45 offen nt
  v_mfma_f32_16x16x32_bf16 v[240:243], v[8:11], v[136:139], 0
  v_mfma_f32_16x16x32_bf16 v[240:243], v[12:15], v[140:143], v[240:243]
  v_and_b32_dpp v18, v16, v238 row_ror:4 row_mask:0xf bank_mask:0xf
  v_and_b32_dpp v19, v16, v239 row_ror:4 row_mask:0xf bank_mask:0xf
  v_and_b32 v17, v16, v237
  v_and_b32 v16, v16, v236
  v_and_b32_dpp v28, v24, v236 row_ror:12 row_mask:0xf bank_mask:0xf
  v_and_b32_dpp v29, v24, v237 row_ror:12 row_mask:0xf bank_mask:0xf
  v_and_b32 v30, v24, v238
  v_and_b32 v31, v24, v239
  v_and_b32_dpp v26, v24, v238 row_ror:4 row_mask:0xf bank_mask:0xf
  v_and_b32_dpp v27, v24, v239 row_ror:4 row_mask:0xf bank_mask:0xf
  v_and_b32 v25, v24, v237
  v_and_b32 v24, v24, v236
  v_and_b32_dpp v36, v32, v236 row_ror:12 row_mask:0xf bank_mask:0xf
  v_and_b32_dpp v37, v32, v237 row_ror:12 row_mask:0xf bank_mask:0xf
  v_and_b32 v38, v32, v238
  v_and_b32 v39, v32, v239
  v_and_b32_dpp v34, v32, v238 row_ror:4 row_mask:0xf bank_mask:0xf
  v_and_b32_dpp v35, v32, v239 row_ror:4 row_mask:0xf bank_mask:0xf
  v_and_b32 v33, v32, v237
  v_and_b32 v32, v32, v236
  v_and_b32_dpp v44, v40, v236 row_ror:12 row_mask:0xf bank_mask:0xf
  v_and_b32_dpp v45, v40, v237 row_ror:12 row_mask:0xf bank_mask:0xf
  v_and_b32 v46, v40, v238
  v_and_b32 v47, v40, v239
  v_and_b32_dpp v42, v40, v238 row_ror:4 row_mask:0xf bank_mask:0xf
  v_and_b32_dpp v43, v40, v239 row_ror:4 row_mask:0xf bank_mask:0xf
  v_and_b32 v41, v40, v237
  v_and_b32 v40, v40, v236
  v_and_b32_dpp v52, v48, v236 row_ror:12 row_mask:0xf bank_mask:0xf
  v_and_b32_dpp v53, v48, v237 row_ror:12 row_mask:0xf bank_mask:0xf
  v_and_b32 v54, v48, v238
  v_and_b32 v55, v48, v239
  v_and_b32_dpp v50, v48, v238 row_ror:4 row_mask:0xf bank_mask:0xf
  v_and_b32_dpp v51, v48, v239 row_ror:4 row_mask:0xf bank_mask:0xf
  v_and_b32 v49, v48, v237
  v_and_b32 v48, v48, v236
  v_and_b32_dpp v60, v56, v236 row_ror:12 row_mask:0xf bank_mask:0xf
  v_and_b32_dpp v61, v56, v237 row_ror:12 row_mask:0xf bank_mask:0xf
  v_and_b32 v62, v56, v238
  v_and_b32 v63, v56, v239
  v_and_b32_dpp v58, v56, v238 row_ror:4 row_mask:0xf bank_mask:0xf
  v_and_b32_dpp v59, v56, v239 row_ror:4 row_mask:0xf bank_mask:0xf
  v_and_b32 v57, v56, v237
  v_and_b32 v56, v56, v236
  s_xor_b32 s45, s17, 282624
  s_cmp_gt_i32 s95, 7
  s_cselect_b32 s44, 0, 4
L_w63:
  s_getreg_b32 s39, hwreg(HW_REG_IB_STS, 0, 4)
  s_cmp_le_u32 s39, 6
  s_cbranch_scc1 L_b63
  s_sub_u32 s44, s44, 1
  s_cbranch_scc0 L_w63
L_b63:
  s_waitcnt vmcnt(9)
  buffer_load_dwordx4 v[204:207], v2, s[8:11], s45 offen nt
  v_mfma_f32_16x16x32_bf16 v[240:243], v[16:19], v[144:147], v[240:243]
  v_mfma_f32_16x16x32_bf16 v[240:243], v[20:23], v[148:151], v[240:243]
  v_mfma_f32_16x16x32_bf16 v[240:243], v[24:27], v[152:155], v[240:243]
  v_mfma_f32_16x16x32_bf16 v[240:243], v[28:31], v[156:159], v[240:243]
  v_mfma_f32_16x16x32_bf16 v[240:243], v[32:35], v[160:163], v[240:243]
  v_mfma_f32_16x16x32_bf16 v[240:243], v[36:39], v[164:167], v[240:243]
  v_and_b32_dpp v68, v64, v236 row_ror:12 row_mask:0xf bank_mask:0xf
  v_and_b32_dpp v69, v64, v237 row_ror:12 row_mask:0xf bank_mask:0xf
  v_and_b32 v70, v64, v238
  v_and_b32 v71, v64, v239
  v_and_b32_dpp v66, v64, v238 row_ror:4 row_mask:0xf bank_mask:0xf
  v_and_b32_dpp v67, v64, v239 row_ror:4 row_mask:0xf bank_mask:0xf
  v_and_b32 v65, v64, v237
  v_and_b32 v64, v64, v236
  v_and_b32_dpp v76, v72, v236 row_ror:12 row_mask:0xf bank_mask:0xf
  v_and_b32_dpp v77, v72, v237 row_ror:12 row_mask:0xf bank_mask:0xf
  v_and_b32 v78, v72, v238
  v_and_b32 v79, v72, v239
  v_and_b32_dpp v74, v72, v238 row_ror:4 row_mask:0xf bank_mask:0xf
  v_and_b32_dpp v75, v72, v239 row_ror:4 row_mask:0xf bank_mask:0xf
  v_and_b32 v73, v72, v237
  v_and_b32 v72, v72, v236
  v_and_b32_dpp v84, v80, v236 row_ror:12 row_mask:0xf bank_mask:0xf
  v_and_b32_dpp v85, v80, v237 row_ror:12 row_mask:0xf bank_mask:0xf
  v_and_b32 v86, v80, v238
  v_and_b32 v87, v80, v239
  v_and_b32_dpp v82, v80, v238 row_ror:4 row_mask:0xf bank_mask:0xf
  v_and_b32_dpp v83, v80, v239 row_ror:4 row_mask:0xf bank_mask:0xf
  v_and_b32 v81, v80, v237
  v_and_b32 v80, v80, v236
  v_and_b32_dpp v92, v88, v236 row_ror:12 row_mask:0xf bank_mask:0xf
  v_and_b32_dpp v93, v88, v237 row_ror:12 row_mask:0xf bank_mask:0xf
  v_and_b32 v94, v88, v238
  v_and_b32 v95, v88, v239
  s_xor_b32 s45, s17, 303104
  s_cmp_gt_i32 s95, 8
  s_cselect_b32 s44, 0, 4
L_w64:
  s_getreg_b32 s39, hwreg(HW_REG_IB_STS, 0, 4)
  s_cmp_le_u32 s39, 6
  s_cbranch_scc1 L_b64
  s_sub_u32 s44, s44, 1
  s_cbranch_scc0 L_w64
L_b64:
  s_waitcnt vmcnt(9)
  buffer_load_dwordx4 v[208:211], v2, s[8:11], s45 offen nt
  v_mfma_f32_16x16x32_bf16 v[240:243], v[40:43], v[168:171], v[240:243]
  v_and_b32_dpp v90, v88, v238 row_ror:4 row_mask:0xf bank_mask:0xf
  v_and_b32_dpp v91, v88, v239 row_ror:4 row_mask:0xf bank_mask:0xf
  v_and_b32 v89, v88, v237
  v_and_b32 v88, v88, v236
  v_and_b32_dpp v100, v96, v236 row_ror:12 row_mask:0xf bank_mask:0xf
  v_and_b32_dpp v101, v96, v237 row_ror:12 row_mask:0xf bank_mask:0xf
  v_and_b32 v102, v96, v238
  v_and_b32 v103, v96, v239
  v_and_b32_dpp v98, v96, v238 row_ror:4 row_mask:0xf bank_mask:0xf
  v_and_b32_dpp v99, v96, v239 row_ror:4 row_mask:0xf bank_mask:0xf
  v_and_b32 v97, v96, v237
  v_and_b32 v96, v96, v236
  v_and_b32_dpp v108, v104, v236 row_ror:12 row_mask:0xf bank_mask:0xf
  v_and_b32_dpp v109, v104, v237 row_ror:12 row_mask:0xf bank_mask:0xf
  v_and_b32 v110, v104, v238
  v_and_b32 v111, v104, v239
  v_and_b32_dpp v106, v104, v238 row_ror:4 row_mask:0xf bank_mask:0xf
  v_and_b32_dpp v107, v104, v239 row_ror:4 row_mask:0xf bank_mask:0xf
  v_and_b32 v105, v104, v237
  v_and_b32 v104, v104, v236
  v_and_b32_dpp v116, v112, v236 row_ror:12 row_mask:0xf bank_mask:0xf
  v_and_b32_dpp v117, v112, v237 row_ror:12 row_mask:0xf bank_mask:0xf
  v_and_b32 v118, v112, v238
  v_and_b32 v119, v112, v239
  v_and_b32_dpp v114, v112, v238 row_ror:4 row_mask:0xf bank_mask:0xf
  v_and_b32_dpp v115, v112, v239 row_ror:4 row_mask:0xf bank_mask:0xf
  v_and_b32 v113, v112, v237
  v_and_b32 v112, v112, v236
  v_and_b32_dpp v124, v120, v236 row_ror:12 row_mask:0xf bank_mask:0xf
  v_and_b32_dpp v125, v120, v237 row_ror:12 row_mask:0xf bank_mask:0xf
  v_and_b32 v126, v120, v238
  v_and_b32 v127, v120, v239
  v_and_b32_dpp v122, v120, v238 row_ror:4 row_mask:0xf bank_mask:0xf
  v_and_b32_dpp v123, v120, v239 row_ror:4 row_mask:0xf bank_mask:0xf
  v_and_b32 v121, v120, v237
  v_and_b32 v120, v120, v236
  v_and_b32_dpp v132, v128, v236 row_ror:12 row_mask:0xf bank_mask:0xf
  v_and_b32_dpp v133, v128, v237 row_ror:12 row_mask:0xf bank_mask:0xf
  v_and_b32 v134, v128, v238
  v_and_b32 v135, v128, v239
  v_and_b32_dpp v130, v128, v238 row_ror:4 row_mask:0xf bank_mask:0xf
  v_and_b32_dpp v131, v128, v239 row_ror:4 row_mask:0xf bank_mask:0xf
  v_and_b32 v129, v128, v237
  v_and_b32 v128, v128, v236
  ds_read_b32 v1, v7 offset:40
  v_lshrrev_b32 v3, 5, v0
  v_and_b32 v4, 15, v0
  v_lshlrev_b32 v4, 1, v4
  s_xor_b32 s45, s17, 323584
  s_cmp_gt_i32 s95, 9
  s_cselect_b32 s44, 0, 4
L_w65:
  s_getreg_b32 s39, hwreg(HW_REG_IB_STS, 0, 4)
  s_cmp_le_u32 s39, 6
  s_cbranch_scc1 L_b65
  s_sub_u32 s44, s44, 1
  s_cbranch_scc0 L_w65
L_b65:
  s_waitcnt vmcnt(9)
  buffer_load_dwordx4 v[212:215], v2, s[8:11], s45 offen nt
  v_mfma_f32_16x16x32_bf16 v[240:243], v[44:47], v[172:175], v[240:243]
  v_bfe_u32 v5, v0, 4, 1
  v_add_u32 v4, v4, v5
  v_lshl_add_u32 v4, v3, 5, v4
  v_and_b32 v3, 0x30, v4
  v_and_b32 v5, 3, v4
  v_lshl_add_u32 v3, v5, 2, v3
  v_bfe_u32 v5, v4, 2, 2
  v_add_u32 v3, v3, v5
  v_lshlrev_b32 v3, 4, v3
  v_lshlrev_b32 v5, 3, v5
  v_lshrrev_b32 v4, v5, s58
  v_xor_b32 v4, 2, v4
  s_lshl_b32 s48, s29, 10
  s_add_u32 s48, s48, 65536
  s_add_u32 s49, s48, 1048576
  s_waitcnt lgkmcnt(0)
  v_readfirstlane_b32 s40, v1
  s_xor_b32 s45, s17, 327680
  s_cmp_gt_i32 s95, 10
  s_cselect_b32 s44, 0, 5
L_w66:
  s_getreg_b32 s39, hwreg(HW_REG_IB_STS, 0, 4)
  s_cmp_le_u32 s39, 4
  s_cbranch_scc1 L_b66
  s_sub_u32 s44, s44, 1
  s_cbranch_scc0 L_w66
L_b66:
  s_waitcnt vmcnt(9)
  buffer_load_dwordx4 v[216:219], v2, s[8:11], s45 offen nt
  v_mfma_f32_16x16x32_bf16 v[240:243], v[48:51], v[176:179], v[240:243]
  s_xor_b32 s45, s17, 348160
  s_cmp_gt_i32 s95, 11
  s_cselect_b32 s44, 0, 8
L_w67:
  s_getreg_b32 s39, hwreg(HW_REG_IB_STS, 0, 4)
  s_cmp_le_u32 s39, 4
  s_cbranch_scc1 L_b67
  s_sub_u32 s44, s44, 1
  s_cbranch_scc0 L_w67
L_b67:
  s_waitcnt vmcnt(9)
  buffer_load_dwordx4 v[220:223], v2, s[8:11], s45 offen nt
  v_mfma_f32_16x16x32_bf16 v[240:243], v[52:55], v[180:183], v[240:243]
  s_xor_b32 s45, s17, 368640
  s_cmp_gt_i32 s95, 12
  s_cselect_b32 s44, 0, 8
L_w68:
  s_getreg_b32 s39, hwreg(HW_REG_IB_STS, 0, 4)
  s_cmp_le_u32 s39, 4
  s_cbranch_scc1 L_b68
  s_sub_u32 s44, s44, 1
  s_cbranch_scc0 L_w68
L_b68:
  s_waitcnt vmcnt(9)
  buffer_load_dwordx4 v[224:227], v2, s[8:11], s45 offen nt
  s_waitcnt vmcnt(8)
  v_sub_u32 v254, v254, v253
  v_cmp_gt_u32 vcc, 64, v254
  s_bcnt1_i32_b32 s94, vcc_lo
  s_max_u32 s95, s94, 16
  s_sub_u32 s95, s95, 16
  s_mul_i32 s95, s95, s95
  s_mul_i32 s95, s95, 5
  s_lshr_b32 s95, s95, 7
  v_mfma_f32_16x16x32_bf16 v[240:243], v[56:59], v[184:187], v[240:243]
  s_xor_b32 s45, s17, 389120
  s_cmp_gt_i32 s95, 0
  s_cselect_b32 s44, 0, 7
L_w69:
  s_getreg_b32 s39, hwreg(HW_REG_IB_STS, 0, 4)
  s_cmp_le_u32 s39, 4
  s_cbranch_scc1 L_b69
  s_sub_u32 s44, s44, 1
  s_cbranch_scc0 L_w69
L_b69:
  s_waitcnt vmcnt(7)
  buffer_load_dwordx4 v[136:139], v2, s[8:11], s45 offen nt
  v_mfma_f32_16x16x32_bf16 v[240:243], v[60:63], v[188:191], v[240:243]
  v_mfma_f32_16x16x32_bf16 v[240:243], v[64:67], v[192:195], v[240:243]
  v_mfma_f32_16x16x32_bf16 v[240:243], v[68:71], v[196:199], v[240:243]
  ds_write_b32 v7, v251 offset:36
  s_xor_b32 s45, s17, 393216
  s_cmp_gt_i32 s95, 1
  s_cselect_b32 s44, 0, 7
L_w70:
  s_getreg_b32 s39, hwreg(HW_REG_IB_STS, 0, 4)
  s_cmp_le_u32 s39, 4
  s_cbranch_scc1 L_b70
  s_sub_u32 s44, s44, 1
  s_cbranch_scc0 L_w70
L_b70:
  s_waitcnt vmcnt(7)
  buffer_load_dwordx4 v[140:143], v2, s[8:11], s45 offen nt
  v_mfma_f32_16x16x32_bf16 v[240:243], v[72:75], v[200:203], v[240:243]
  s_xor_b32 s45, s17, 413696
  s_cmp_gt_i32 s95, 2
  s_cselect_b32 s44, 0, 8
L_w71:
  s_getreg_b32 s39, hwreg(HW_REG_IB_STS, 0, 4)
  s_cmp_le_u32 s39, 4
  s_cbranch_scc1 L_b71
  s_sub_u32 s44, s44, 1
  s_cbranch_scc0 L_w71
L_b71:
  s_waitcnt vmcnt(7)
  buffer_load_dwordx4 v[144:147], v2, s[8:11], s45 offen nt
  v_mfma_f32_16x16x32_bf16 v[240:243], v[76:79], v[204:207], v[240:243]
  s_xor_b32 s45, s17, 434176
  s_cmp_gt_i32 s95, 3
  s_cselect_b32 s44, 0, 8
L_w72:
  s_getreg_b32 s39, hwreg(HW_REG_IB_STS, 0, 4)
  s_cmp_le_u32 s39, 4
  s_cbranch_scc1 L_b72
  s_sub_u32 s44, s44, 1
  s_cbranch_scc0 L_w72
L_b72:
  s_waitcnt vmcnt(7)
  buffer_load_dwordx4 v[148:151], v2, s[8:11], s45 offen nt
  v_mfma_f32_16x16x32_bf16 v[240:243], v[80:83], v[208:211], v[240:243]
  s_xor_b32 s45, s17, 454656
  s_cmp_gt_i32 s95, 4
  s_cselect_b32 s44, 0, 8
L_w73:
  s_getreg_b32 s39, hwreg(HW_REG_IB_STS, 0, 4)
  s_cmp_le_u32 s39, 4
  s_cbranch_scc1 L_b73
  s_sub_u32 s44, s44, 1
  s_cbranch_scc0 L_w73
L_b73:
  s_waitcnt vmcnt(7)
  buffer_load_dwordx4 v[152:155], v2, s[8:11], s45 offen nt
  v_mfma_f32_16x16x32_bf16 v[240:243], v[84:87], v[212:215], v[240:243]
  s_xor_b32 s45, s17, 458752
  s_cmp_gt_i32 s95, 5
  s_cselect_b32 s44, 0, 8
L_w74:
  s_getreg_b32 s39, hwreg(HW_REG_IB_STS, 0, 4)
  s_cmp_le_u32 s39, 4
  s_cbranch_scc1 L_b74
  s_sub_u32 s44, s44, 1
  s_cbranch_scc0 L_w74
L_b74:
  s_waitcnt vmcnt(7)
  buffer_load_dwordx4 v[156:159], v2, s[8:11], s45 offen nt
  v_mfma_f32_16x16x32_bf16 v[240:243], v[88:91], v[216:219], v[240:243]
  s_xor_b32 s45, s17, 479232
  s_cmp_gt_i32 s95, 6
  s_cselect_b32 s44, 0, 8
L_w75:
  s_getreg_b32 s39, hwreg(HW_REG_IB_STS, 0, 4)
  s_cmp_le_u32 s39, 4
  s_cbranch_scc1 L_b75
  s_sub_u32 s44, s44, 1
  s_cbranch_scc0 L_w75
L_b75:
  s_waitcnt vmcnt(7)
  buffer_load_dwordx4 v[160:163], v2, s[8:11], s45 offen nt
  v_mfma_f32_16x16x32_bf16 v[240:243], v[92:95], v[220:223], v[240:243]
  s_xor_b32 s45, s17, 499712
  s_cmp_gt_i32 s95, 7
  s_cselect_b32 s44, 0, 8
L_w76:
  s_getreg_b32 s39, hwreg(HW_REG_IB_STS, 0, 4)
  s_cmp_le_u32 s39, 4
  s_cbranch_scc1 L_b76
  s_sub_u32 s44, s44, 1
  s_cbranch_scc0 L_w76
L_b76:
  s_waitcnt vmcnt(7)
  buffer_load_dwordx4 v[164:167], v2, s[8:11], s45 offen nt
  v_mfma_f32_16x16x32_bf16 v[240:243], v[96:99], v[224:227], v[240:243]
  s_xor_b32 s45, s17, 520192
  s_cmp_gt_i32 s95, 8
  s_cselect_b32 s44, 0, 8
L_w77:
  s_getreg_b32 s39, hwreg(HW_REG_IB_STS, 0, 4)
  s_cmp_le_u32 s39, 4
  s_cbranch_scc1 L_b77
  s_sub_u32 s44, s44, 1
  s_cbranch_scc0 L_w77
L_b77:
  s_waitcnt vmcnt(7)
  buffer_load_dwordx4 v[168:171], v2, s[8:11], s45 offen nt
  v_mfma_f32_16x16x32_bf16 v[240:243], v[100:103], v[136:139], v[240:243]
  s_waitcnt vmcnt(7)
  v_mfma_f32_16x16x32_bf16 v[240:243], v[104:107], v[140:143], v[240:243]
  s_waitcnt vmcnt(6)
  v_mfma_f32_16x16x32_bf16 v[240:243], v[108:111], v[144:147], v[240:243]
  s_waitcnt vmcnt(5)
  v_mfma_f32_16x16x32_bf16 v[240:243], v[112:115], v[148:151], v[240:243]
  s_waitcnt vmcnt(4)
  v_mfma_f32_16x16x32_bf16 v[240:243], v[116:119], v[152:155], v[240:243]
  s_waitcnt vmcnt(3)
  v_mfma_f32_16x16x32_bf16 v[240:243], v[120:123], v[156:159], v[240:243]
  s_waitcnt vmcnt(2)
  ds_write_b32 v250, v251 offset:48
  v_mfma_f32_16x16x32_bf16 v[240:243], v[124:127], v[160:163], v[240:243]
  s_waitcnt vmcnt(1)
  v_mfma_f32_16x16x32_bf16 v[240:243], v[128:131], v[164:167], v[240:243]
  s_waitcnt vmcnt(0)
  v_mfma_f32_16x16x32_bf16 v[240:243], v[132:135], v[168:171], v[240:243]
  s_cmp_eq_u32 s3, 4
  s_cbranch_scc1 L_red
  s_nop 5
  ds_write_b128 v6, v[240:243]
  s_waitcnt lgkmcnt(0)
  s_barrier
  s_branch L_final
L_red:
  s_cmp_eq_u32 s40, 2
  s_barrier
  ds_read_b128 v[28:31], v6 offset:1024
  ds_read_b128 v[32:35], v6 offset:2048
  ds_read_b128 v[36:39], v6 offset:3072
  s_waitcnt lgkmcnt(2)
  v_pk_add_f32 v[240:241], v[240:241], v[28:29]
  v_pk_add_f32 v[242:243], v[242:243], v[30:31]
  s_waitcnt lgkmcnt(1)
  v_pk_add_f32 v[240:241], v[240:241], v[32:33]
  v_pk_add_f32 v[242:243], v[242:243], v[34:35]
  s_waitcnt lgkmcnt(0)
  v_pk_add_f32 v[240:241], v[240:241], v[36:37]
  v_pk_add_f32 v[242:243], v[242:243], v[38:39]
  v_bfi_b32 v240, v251, v4, v240
  buffer_store_dwordx4 v[240:243], v3, s[24:27], s48 offen
  s_cbranch_scc1 L_of
  buffer_store_dwordx4 v[240:243], v3, s[24:27], s49 offen sc1
L_of:
  ds_write_b32 v7, v251 offset:44
L_final:
  s_sub_u32 s90, 7, s3
  s_lshl_b32 s91, s90, 2
  v_lshrrev_b32 v113, 4, v0
  v_add_u32 v113, s91, v113
  v_and_b32 v114, 15, v0
  v_mul_u32_u24 v115, 15, v113
  v_add_u32 v115, v115, v114
  v_lshlrev_b32 v113, 7, v113
  v_lshl_add_u32 v113, v114, 2, v113
  v_cmp_eq_u32 s[84:85], 15, v114
  v_cmp_gt_u32 vcc, 0x100, v115
  v_lshrrev_b32 v116, 6, v115
  v_and_b32 v117, 63, v115
  s_andn2_b64 s[86:87], vcc, s[84:85]
  v_cmp_gt_u32 vcc, 2304, v113
  v_mul_u32_u24 v118, 1152, v116
  v_lshl_add_u32 v118, v117, 1, v118
  s_and_b64 s[84:85], s[84:85], vcc
  s_lshl_b32 s92, s33, 7
  s_or_b64 s[88:89], s[84:85], s[86:87]
  s_add_u32 s91, s92, 118080
  v_add_u32 v120, s91, v118
  ds_read_u16 v121, v120
  ds_read_u16 v122, v120 offset:128
  v_and_b32 v119, 0x30, v117
  v_lshlrev_b32 v119, 2, v119
  v_lshl_add_u32 v119, v116, 4, v119
  v_and_b32 v120, 15, v117
  v_add_u32 v119, v119, v120
  v_lshlrev_b32 v119, 2, v119
  v_add_u32 v119, 113984, v119
  s_mul_i32 s91, s33, 2304
  s_add_u32 s91, s91, 4096
  s_or_b32 s90, s90, s33
  s_waitcnt lgkmcnt(0)
  v_lshlrev_b32 v121, 16, v121
  v_lshlrev_b32 v122, 16, v122
  s_barrier
  ds_read2st64_b32 v[12:13], v119 offset0:0 offset1:4
  ds_read2st64_b32 v[14:15], v119 offset0:8 offset1:12
L_final2:
  s_mov_b64 exec, s[88:89]
  s_cmp_eq_u32 s32, 3
  s_cbranch_scc1 L_f2
  s_waitcnt lgkmcnt(0)
  v_add_f32 v12, v12, v14
  v_add_f32 v13, v13, v15
  v_add_f32 v12, v12, v13
L_f0:
  v_cndmask_b32 v13, v12, 1.0, s[84:85]
  buffer_atomic_add_f32 v13, v113, s[24:27], s91 offen sc0 sc1
  v_add_f32 v12, v12, v121
  s_waitcnt vmcnt(0)
L_f1:
  v_mov_b32_dpp v16, v13 row_newbcast:15 row_mask:0xf bank_mask:0xf
  v_add_f32 v12, v12, v13
  v_cmp_eq_f32 vcc, 0x41f80000, v16
  v_cvt_pk_bf16_f32 v12, v12, v12
  s_and_b64 exec, vcc, s[86:87]
  s_cbranch_execz L_fin
  buffer_store_short v12, v118, s[20:23], s92 offen offset:0
  s_cmp_lg_u32 s90, 0
  s_cbranch_scc1 L_fin
  s_and_b64 exec, exec, 1
  s_cbranch_execz L_fin
  v_mov_b32 v12, s58
  buffer_store_dword v12, v113, s[24:27], 0 offen
  s_branch L_fin
L_f2:
  s_cmp_eq_u32 s33, 8
  s_waitcnt lgkmcnt(0)
  v_add_f32 v12, v12, v13
  s_cbranch_scc1 L_f0
  v_add_f32 v14, v14, v15
  v_cndmask_b32 v13, v12, 1.0, s[84:85]
  v_cndmask_b32 v15, v14, 1.0, s[84:85]
  buffer_atomic_add_f32 v13, v113, s[24:27], s91 offen sc0 sc1
  buffer_atomic_add_f32 v15, v113, s[24:27], s91 offen offset:2304 sc0 sc1
  v_add_f32 v12, v12, v121
  v_add_f32 v14, v14, v122
  s_waitcnt vmcnt(0)
  v_mov_b32_dpp v16, v15 row_newbcast:15 row_mask:0xf bank_mask:0xf
  v_add_f32 v14, v14, v15
  v_cmp_eq_f32 vcc, 0x41f80000, v16
  v_cvt_pk_bf16_f32 v14, v14, v14
  s_and_b64 exec, vcc, s[86:87]
  s_cbranch_execz L_f3
  buffer_store_short v14, v118, s[20:23], s92 offen offset:128
L_f3:
  s_mov_b64 exec, s[88:89]
  s_branch L_f1
L_aux:
  s_mul_i32 s36, s3, 1152
  v_lshlrev_b32 v7, 2, v0
  v_add_u32 v5, 109696, v7
  v_mov_b32 v6, 0
  s_mov_b32 s43, 0x20000
  s_cmp_lg_u32 s3, 0
  s_cbranch_scc1 L_noi
  s_mov_b32 exec_hi, 0xffff
  ds_write_b32 v5, v6
  s_mov_b32 exec_hi, -1
L_noi:
  s_waitcnt lgkmcnt(0)
  s_add_u32 s4, s4, s36
  s_addc_u32 s5, s5, 0
  s_movk_i32 s6, 1152
  s_mov_b32 s7, s43
  s_load_dword s58, s[24:25], 0
  buffer_load_dwordx4 v[8:11], v2, s[4:7], 0 offen
  buffer_load_dword v12, v7, s[4:7], 0 offen offset:1024
  s_barrier
  s_lshl_b32 s36, s3, 8
  s_add_u32 s36, s36, s29
  s_cmp_ge_u32 s36, 9
  s_waitcnt vmcnt(0)
  s_cbranch_scc1 L_noz
  v_mov_b32 v28, 0
  v_mov_b32 v29, 0
  v_mov_b32 v30, 0
  v_mov_b32 v31, 0
  s_mul_i32 s36, s29, 2304
  s_add_u32 s26, s36, 6400
  s_add_u32 s36, s36, 4096
  s_mov_b32 s27, s43
  buffer_store_dwordx4 v[28:31], v2, s[24:27], s36 offen sc1
  buffer_store_dwordx4 v[28:31], v2, s[24:27], s36 offen offset:1024 sc1
  buffer_store_dwordx4 v[28:31], v2, s[24:27], s36 offen offset:2048 sc1
L_noz:
  s_mul_i32 s36, s3, 1152
  s_add_u32 s36, s36, 118080
  v_add_u32 v13, s36, v2
  v_add_u32 v14, s36, v7
  ds_write_b128 v13, v[8:11]
  s_mov_b32 exec_hi, 0
  ds_write_b32 v14, v12 offset:1024
  s_mov_b32 exec_hi, -1
  s_and_b32 s35, s30, 1
  s_mul_i32 s35, s35, 7
  s_add_u32 s35, s35, s31
  s_sub_u32 s33, s35, 9
  s_sub_u32 s34, s35, 18
  s_lshl_b32 s34, s34, 1
  s_cmp_lt_u32 s35, 18
  s_cselect_b32 s32, 2, 3
  s_cselect_b32 s33, s33, s34
  s_cmp_lt_u32 s31, 9
  s_cselect_b32 s32, 1, s32
  s_cselect_b32 s33, s31, s33
  s_mov_b32 s26, 1900544
  s_mov_b32 s27, 0x20000
  s_movk_i32 s22, 4608
  s_mov_b32 s23, s27
  s_mov_b32 s59, 0
  s_mov_b32 s57, 1069066811
  v_lshlrev_b32 v14, 16, v8
  v_and_b32 v15, 0xffff0000, v8
  v_lshlrev_b32 v16, 16, v9
  v_and_b32 v17, 0xffff0000, v9
  v_lshlrev_b32 v18, 16, v10
  v_and_b32 v19, 0xffff0000, v10
  v_lshlrev_b32 v20, 16, v11
  v_and_b32 v21, 0xffff0000, v11
  v_lshlrev_b32 v22, 16, v12
  v_and_b32 v23, 0xffff0000, v12
  v_add_f32 v24, v14, v15
  v_add_f32 v25, v16, v17
  v_add_f32 v24, v24, v18
  v_add_f32 v25, v25, v19
  v_add_f32 v24, v24, v20
  v_add_f32 v25, v25, v21
  v_add_f32 v24, v24, v22
  v_add_f32 v25, v25, v23
  v_add_f32 v24, v24, v25
  s_nop 1
  v_add_f32_dpp v24, v24, v24 row_ror:8 row_mask:0xf bank_mask:0xf
  s_nop 1
  v_add_f32_dpp v24, v24, v24 row_ror:4 row_mask:0xf bank_mask:0xf
  s_nop 1
  v_add_f32_dpp v24, v24, v24 row_ror:2 row_mask:0xf bank_mask:0xf
  s_nop 1
  v_add_f32_dpp v24, v24, v24 row_ror:1 row_mask:0xf bank_mask:0xf
  v_mov_b32 v25, v24
  s_nop 1
  v_permlane16_swap_b32 v24, v25
  v_add_f32 v24, v24, v25
  v_mov_b32 v25, v24
  s_nop 1
  v_permlane32_swap_b32 v24, v25
  v_add_f32 v24, v24, v25
  v_mul_f32 v24, 0x3ae38e39, v24
  v_sub_f32 v26, v14, v24
  v_mul_f32 v25, v26, v26
  v_sub_f32 v26, v15, v24
  v_fmac_f32 v25, v26, v26
  v_sub_f32 v26, v16, v24
  v_fmac_f32 v25, v26, v26
  v_sub_f32 v26, v17, v24
  v_fmac_f32 v25, v26, v26
  v_sub_f32 v26, v18, v24
  v_fmac_f32 v25, v26, v26
  v_sub_f32 v26, v19, v24
  v_fmac_f32 v25, v26, v26
  v_sub_f32 v26, v20, v24
  v_fmac_f32 v25, v26, v26
  v_sub_f32 v26, v21, v24
  v_fmac_f32 v25, v26, v26
  s_mov_b32 exec_hi, 0
  v_sub_f32 v26, v22, v24
  v_fmac_f32 v25, v26, v26
  v_sub_f32 v26, v23, v24
  v_fmac_f32 v25, v26, v26
  s_mov_b32 exec_hi, -1
  s_nop 0
  v_add_f32_dpp v25, v25, v25 row_ror:8 row_mask:0xf bank_mask:0xf
  s_nop 1
  v_add_f32_dpp v25, v25, v25 row_ror:4 row_mask:0xf bank_mask:0xf
  s_nop 1
  v_add_f32_dpp v25, v25, v25 row_ror:2 row_mask:0xf bank_mask:0xf
  s_nop 1
  v_add_f32_dpp v25, v25, v25 row_ror:1 row_mask:0xf bank_mask:0xf
  v_mov_b32 v26, v25
  s_nop 1
  v_permlane16_swap_b32 v25, v26
  v_add_f32 v25, v25, v26
  v_mov_b32 v26, v25
  s_nop 1
  v_permlane32_swap_b32 v25, v26
  v_add_f32 v25, v25, v26
  v_mul_f32 v25, 0x3ae38e39, v25
  v_cvt_pk_bf16_f32 v24, 0, v24
  v_cvt_pk_bf16_f32 v25, 0, v25
  v_add_f32 v25, 0x3727c5ac, v25
  v_cvt_pk_bf16_f32 v25, 0, v25
  v_sqrt_f32 v25, v25
  s_nop 0
  v_cvt_pk_bf16_f32 v25, 0, v25
  v_rcp_f32 v25, v25
  v_sub_f32 v14, v14, v24
  v_sub_f32 v15, v15, v24
  v_sub_f32 v16, v16, v24
  v_sub_f32 v17, v17, v24
  v_sub_f32 v18, v18, v24
  v_sub_f32 v19, v19, v24
  v_sub_f32 v20, v20, v24
  v_sub_f32 v21, v21, v24
  v_sub_f32 v22, v22, v24
  v_sub_f32 v23, v23, v24
  v_cvt_pk_bf16_f32 v14, 0, v14
  v_cvt_pk_bf16_f32 v15, 0, v15
  v_cvt_pk_bf16_f32 v16, 0, v16
  v_cvt_pk_bf16_f32 v17, 0, v17
  v_cvt_pk_bf16_f32 v18, 0, v18
  v_cvt_pk_bf16_f32 v19, 0, v19
  v_cvt_pk_bf16_f32 v20, 0, v20
  v_cvt_pk_bf16_f32 v21, 0, v21
  v_cvt_pk_bf16_f32 v22, 0, v22
  v_cvt_pk_bf16_f32 v23, 0, v23
  v_mul_f32 v14, v14, v25
  v_mul_f32 v15, v15, v25
  v_mul_f32 v16, v16, v25
  v_mul_f32 v17, v17, v25
  v_mul_f32 v18, v18, v25
  v_mul_f32 v19, v19, v25
  v_mul_f32 v20, v20, v25
  v_mul_f32 v21, v21, v25
  v_mul_f32 v22, v22, v25
  v_mul_f32 v23, v23, v25
  v_cvt_pk_bf16_f32 v8, v14, v15
  v_cvt_pk_bf16_f32 v9, v16, v17
  v_cvt_pk_bf16_f32 v10, v18, v19
  v_cvt_pk_bf16_f32 v11, v20, v21
  v_cvt_pk_bf16_f32 v12, v22, v23
  s_mul_i32 s36, s3, 1184
  s_add_u32 s36, s36, 104448
  v_add_u32 v13, s36, v2
  v_add_u32 v14, s36, v7
  s_waitcnt lgkmcnt(0)
  ds_write_b128 v13, v[8:11]
  s_mov_b32 exec_hi, 0
  ds_write_b32 v14, v12 offset:1024
  s_mov_b32 exec_hi, -1
  s_add_u32 s58, s58, 0x9E3779B9
  s_and_b32 s60, s58, 0xff
  s_bfe_u32 s61, s58, 0x80008
  s_bfe_u32 s62, s58, 0x80010
  s_lshr_b32 s63, s58, 24
  s_getreg_b32 s56, hwreg(HW_REG_XCC_ID, 0, 3)
  s_xor_b32 s56, s56, s58
  v_mov_b32 v13, 109696
  v_lshl_add_u32 v15, s3, 2, v13
  v_mov_b32 v14, s58
  v_mov_b32 v61, 0xff
  v_mov_b32 v113, 0
  v_mov_b32 v118, 0
  v_mov_b32 v119, 0
  s_waitcnt lgkmcnt(0)
  ds_write_b32 v15, v61
  s_cmp_eq_u32 s3, 2
  s_cbranch_scc1 L_pollq
  s_cmp_eq_u32 s3, 3
  s_cbranch_scc1 L_init
  s_mul_i32 s44, s30, 9
  s_add_u32 s44, s44, s31
  s_lshl_b32 s36, s46, 6
  s_and_b32 s37, s44, 1
  s_mul_i32 s37, s37, 576
  s_lshl4_add_u32 s38, s30, s45
  s_lshl_b32 s38, s38, 10
  s_add_u32 s38, s38, 65536
  s_lshl_b32 s39, s44, 10
  s_add_u32 s39, s39, 327680
  s_cmp_eq_u32 s3, 0
  s_cselect_b32 s36, s36, s37
  s_cselect_b32 s38, s38, s39
  s_cselect_b32 s37, 0, 18432
  s_cselect_b32 s39, s94, 9
  s_cselect_b32 s40, 1, s32
  s_cmp_lg_u32 s40, 1
  s_cbranch_scc1 L_cons
  s_add_u32 s36, s36, 104448
  v_and_b32 v3, 3, v0
  v_mul_u32_u24 v4, 1184, v3
  v_lshrrev_b32 v5, 4, v0
  v_lshl_add_u32 v4, v5, 3, v4
  v_add_u32 v4, s36, v4
  v_lshlrev_b32 v6, 8, v3
  v_lshl_add_u32 v6, v5, 6, v6
  v_bfe_u32 v5, v0, 2, 2
  v_lshl_add_u32 v6, v5, 4, v6
  s_mul_i32 s40, s3, -48
  s_add_u32 s40, s40, 64
  v_add_u32 v15, s40, v13
  v_lshlrev_b32 v83, 3, v5
  v_lshrrev_b32 v83, v83, s58
  v_bfe_u32 v80, v83, 0, 2
  v_bfe_u32 v81, v83, 2, 2
  v_bfe_u32 v82, v83, 4, 2
  v_bfe_u32 v83, v83, 6, 2
  v_lshrrev_b32 v8, 2, v0
  v_and_b32 v9, 6, v8
  v_bfe_u32 v10, v0, 1, 1
  v_or_b32 v9, v9, v10
  v_lshlrev_b32 v9, 4, v9
  v_lshl_add_u32 v8, v8, 7, v9
  v_and_b32 v9, 1, v0
  v_lshl_add_u32 v8, v9, 3, v8
  v_add_u32 v8, s37, v8
  v_xor_b32 v9, 32, v8
  v_xor_b32 v10, 64, v8
  v_xor_b32 v11, 0x60, v8
  v_mov_b32 v64, 0
  v_mov_b32 v65, 0
  v_mov_b32 v66, 0
  v_mov_b32 v67, 0
  v_mov_b32 v68, 0
  v_mov_b32 v69, 0
  v_mov_b32 v70, 0
  v_mov_b32 v71, 0
  v_mov_b32 v72, 0
  v_mov_b32 v73, 0
  v_mov_b32 v74, 0
  v_mov_b32 v75, 0
  v_mov_b32 v76, 0
  v_mov_b32 v77, 0
  v_mov_b32 v78, 0
  v_mov_b32 v79, 0
L_auxw:
  ds_read_b128 v[16:19], v13 offset:0
  s_add_u32 s59, s59, 1
  s_cmp_gt_u32 s59, 200000
  s_cbranch_scc1 L_exit
  s_waitcnt lgkmcnt(0)
  v_and_b32 v16, v16, v17
  v_and_b32 v18, v18, v19
  v_and_b32 v16, v16, v18
  v_cmp_eq_u32 vcc, 0, v16
  s_cbranch_vccz L_auxw_ok
  s_sleep 1
  s_branch L_auxw
L_auxw_ok:
L_auxw2:
  ds_read_b128 v[16:19], v15 offset:0
  s_add_u32 s59, s59, 1
  s_cmp_gt_u32 s59, 200000
  s_cbranch_scc1 L_exit
  s_waitcnt lgkmcnt(0)
  v_and_b32 v16, v16, v17
  v_and_b32 v18, v18, v19
  v_and_b32 v16, v16, v18
  v_cmp_eq_u32 vcc, 0, v16
  s_cbranch_vccz L_auxw2_ok
  s_sleep 1
  s_branch L_auxw2
L_auxw2_ok:
L_ip:
  ds_read2_b64 v[16:19], v4 offset0:0 offset1:4
  ds_read_b64_tr_b16 v[24:25], v8 offset:0
  ds_read_b64_tr_b16 v[26:27], v8 offset:2048
  ds_read_b64_tr_b16 v[28:29], v9 offset:0
  ds_read_b64_tr_b16 v[30:31], v9 offset:2048
  ds_read_b64_tr_b16 v[32:33], v10 offset:0
  ds_read_b64_tr_b16 v[34:35], v10 offset:2048
  ds_read_b64_tr_b16 v[36:37], v11 offset:0
  ds_read_b64_tr_b16 v[38:39], v11 offset:2048
  v_add_u32 v4, 64, v4
  v_add_u32 v8, 4096, v8
  v_add_u32 v9, 4096, v9
  v_add_u32 v10, 4096, v10
  v_add_u32 v11, 4096, v11
  s_waitcnt lgkmcnt(6)
  v_mfma_f32_16x16x32_bf16 v[64:67], v[24:27], v[16:19], v[64:67]
  s_waitcnt lgkmcnt(4)
  v_mfma_f32_16x16x32_bf16 v[68:71], v[28:31], v[16:19], v[68:71]
  s_waitcnt lgkmcnt(2)
  v_mfma_f32_16x16x32_bf16 v[72:75], v[32:35], v[16:19], v[72:75]
  s_waitcnt lgkmcnt(0)
  v_mfma_f32_16x16x32_bf16 v[76:79], v[36:39], v[16:19], v[76:79]
  s_sub_u32 s39, s39, 1
  s_cmp_lg_u32 s39, 0
  s_cbranch_scc1 L_ip
  s_lshl_b32 s36, s29, 2
  s_add_u32 s36, s36, 28672
  s_lshl_b32 s37, s31, 2
  s_add_u32 s37, s37, 26624
  v_lshlrev_b32 v3, 7, v0
  v_mov_b32 v4, s56
  v_mov_b32_dpp v64, v68 quad_perm:[0,1,2,3] row_mask:0xf bank_mask:2
  v_mov_b32_dpp v65, v69 quad_perm:[0,1,2,3] row_mask:0xf bank_mask:2
  v_mov_b32_dpp v66, v70 quad_perm:[0,1,2,3] row_mask:0xf bank_mask:2
  v_mov_b32_dpp v67, v71 quad_perm:[0,1,2,3] row_mask:0xf bank_mask:2
  v_mov_b32_dpp v64, v72 quad_perm:[0,1,2,3] row_mask:0xf bank_mask:4
  v_mov_b32_dpp v65, v73 quad_perm:[0,1,2,3] row_mask:0xf bank_mask:4
  v_mov_b32_dpp v66, v74 quad_perm:[0,1,2,3] row_mask:0xf bank_mask:4
  v_mov_b32_dpp v67, v75 quad_perm:[0,1,2,3] row_mask:0xf bank_mask:4
  v_mov_b32_dpp v64, v76 quad_perm:[0,1,2,3] row_mask:0xf bank_mask:8
  v_mov_b32_dpp v65, v77 quad_perm:[0,1,2,3] row_mask:0xf bank_mask:8
  v_mov_b32_dpp v66, v78 quad_perm:[0,1,2,3] row_mask:0xf bank_mask:8
  v_mov_b32_dpp v67, v79 quad_perm:[0,1,2,3] row_mask:0xf bank_mask:8
  v_add_u32 v64, 2, v64
  v_add_u32 v65, 2, v65
  v_add_u32 v66, 2, v66
  v_add_u32 v67, 2, v67
  v_bfi_b32 v64, 3, v80, v64
  v_bfi_b32 v65, 3, v81, v65
  v_bfi_b32 v66, 3, v82, v66
  v_bfi_b32 v67, 3, v83, v67
  s_cmp_lg_u32 s3, 0
  s_waitcnt vmcnt(0)
  buffer_store_dwordx4 v[64:67], v6, s[24:27], s38 offen
  s_cbranch_scc1 L_nox
  s_mov_b64 exec, 1
  buffer_store_dword v4, v3, s[24:27], s36 offen
  s_cmp_ge_u32 s29, 9
  s_cbranch_scc1 L_nox
  s_mov_b64 exec, 0xffff
  buffer_store_dword v14, v3, s[24:27], s37 offen sc1
L_nox:
  s_mov_b64 exec, -1
L_pw:
  ds_read_b32 v1, v13 offset:40
  s_add_u32 s59, s59, 1
  s_cmp_gt_u32 s59, 200000
  s_cbranch_scc1 L_exit
  s_waitcnt lgkmcnt(0)
  v_cmp_ne_u32 vcc, 0, v1
  s_cbranch_vccnz L_pw_ok
  s_sleep 8
  s_branch L_pw
L_pw_ok:
  v_cmp_eq_u32 vcc, 2, v1
  s_cbranch_vccnz L_cons
  s_add_u32 s38, s38, 1048576
  buffer_store_dwordx4 v[64:67], v6, s[24:27], s38 offen sc1
  s_branch L_cons
L_init:
L_iq:
  ds_read_b32 v1, v13 offset:32
  s_add_u32 s59, s59, 1
  s_cmp_gt_u32 s59, 200000
  s_cbranch_scc1 L_exit
  s_waitcnt lgkmcnt(0)
  v_cmp_ne_u32 vcc, 0, v1
  s_cbranch_vccnz L_iq_ok
  s_sleep 8
  s_branch L_iq
L_iq_ok:
  s_sub_u32 s90, 7, s3
  s_lshl_b32 s91, s90, 2
  v_lshrrev_b32 v113, 4, v0
  v_add_u32 v113, s91, v113
  v_and_b32 v114, 15, v0
  v_mul_u32_u24 v115, 15, v113
  v_add_u32 v115, v115, v114
  v_lshlrev_b32 v113, 7, v113
  v_lshl_add_u32 v113, v114, 2, v113
  v_cmp_eq_u32 s[84:85], 15, v114
  v_cmp_gt_u32 vcc, 0x100, v115
  v_lshrrev_b32 v116, 6, v115
  v_and_b32 v117, 63, v115
  s_andn2_b64 s[86:87], vcc, s[84:85]
  v_cmp_gt_u32 vcc, 2304, v113
  v_mul_u32_u24 v118, 1152, v116
  v_lshl_add_u32 v118, v117, 1, v118
  s_and_b64 s[84:85], s[84:85], vcc
  s_lshl_b32 s92, s33, 7
  s_or_b64 s[88:89], s[84:85], s[86:87]
  s_add_u32 s91, s92, 118080
  v_add_u32 v120, s91, v118
  ds_read_u16 v121, v120
  ds_read_u16 v122, v120 offset:128
  v_and_b32 v119, 0x30, v117
  v_lshlrev_b32 v119, 2, v119
  v_lshl_add_u32 v119, v116, 4, v119
  v_and_b32 v120, 15, v117
  v_add_u32 v119, v119, v120
  v_lshlrev_b32 v119, 2, v119
  v_add_u32 v119, 113984, v119
  s_mul_i32 s91, s33, 2304
  s_add_u32 s91, s91, 4096
  s_or_b32 s90, s90, s33
  s_waitcnt lgkmcnt(0)
  v_lshlrev_b32 v121, 16, v121
  v_lshlrev_b32 v122, 16, v122
  s_lshl_b32 s36, s30, 7
  s_lshl_b32 s37, s33, 2
  s_add_u32 s36, s36, s37
  s_add_u32 s36, s36, 26624
  s_min_u32 s37, s33, 7
  s_sub_u32 s37, s37, s33
  s_lshl_b32 s37, s37, 2
  s_add_u32 s37, s37, s36
  s_add_u32 s37, s37, 4
L_initw:
  s_load_dword s38, s[24:25], s36 glc
  s_load_dword s39, s[24:25], s37 glc
  s_add_u32 s59, s59, 1
  s_cmp_gt_u32 s59, 200000
  s_cbranch_scc1 L_exit
  s_waitcnt lgkmcnt(0)
  s_xor_b32 s38, s38, s58
  s_xor_b32 s39, s39, s58
  s_or_b32 s38, s38, s39
  s_cbranch_scc0 L_cons
  s_sleep 8
  s_branch L_initw
L_pollq:
  v_lshrrev_b32 v3, 4, v0
  v_and_b32 v4, 15, v0
  v_lshlrev_b32 v4, 4, v4
  v_lshl_add_u32 v4, v3, 12, v4
  v_lshlrev_b32 v3, 7, v3
  v_and_b32 v5, 3, v0
  v_lshl_add_u32 v3, v5, 5, v3
  v_bfe_u32 v5, v0, 2, 2
  v_lshl_add_u32 v3, v5, 3, v3
  v_add_u32 v3, 109184, v3
  v_and_b32 v5, 0x7c, v7
  s_lshl_b32 s36, s30, 14
  s_lshr_b32 s37, s31, 2
  s_lshl_b32 s37, s37, 8
  s_add_u32 s36, s36, s37
  s_add_u32 s36, s36, 65536
  s_lshl_b32 s38, s28, 7
  s_add_u32 s38, s38, 28672
  s_mov_b32 s39, 0
  v_and_b32 v6, 3, v0
  v_lshlrev_b32 v83, 3, v6
  v_lshrrev_b32 v83, v83, s58
  v_bfe_u32 v80, v83, 0, 2
  v_bfe_u32 v81, v83, 2, 2
  v_bfe_u32 v82, v83, 4, 2
  v_bfe_u32 v83, v83, 6, 2
L_qt:
  ds_read_b32 v1, v13 offset:80
  s_add_u32 s59, s59, 1
  s_cmp_gt_u32 s59, 200000
  s_cbranch_scc1 L_exit
  s_waitcnt lgkmcnt(0)
  v_cmp_ne_u32 vcc, 0, v1
  s_cbranch_vccnz L_qt_ok
  s_sleep 4
  s_branch L_qt
L_qt_ok:
  s_mov_b32 s59, 0
L_pq:
  buffer_load_dword v33, v5, s[24:27], s38 offen sc1
  buffer_load_dwordx4 v[16:19], v4, s[24:27], s36 offen offset:0 sc1
  buffer_load_dwordx4 v[20:23], v4, s[24:27], s36 offen offset:1024 sc1
  buffer_load_dwordx4 v[24:27], v4, s[24:27], s36 offen offset:2048 sc1
  buffer_load_dwordx4 v[28:31], v4, s[24:27], s36 offen offset:3072 sc1
  s_add_u32 s59, s59, 1
  s_cmp_gt_u32 s59, 200000
  s_cbranch_scc1 L_exit
  s_waitcnt vmcnt(0)
  s_cmp_lg_u32 s39, 0
  s_cbranch_scc1 L_pq1
  s_cmp_ge_u32 s59, 16
  s_cselect_b32 s39, 1, 0
  v_cmp_ne_u32 vcc, s56, v33
  s_cbranch_vccnz L_pq0
  s_mov_b32 s39, 2
L_pq0:
  s_cmp_eq_u32 s39, 0
  s_cbranch_scc1 L_pq
  v_mov_b32 v33, s39
  ds_write_b32 v13, v33 offset:40
L_pq1:
  s_and_b32 s37, s39, 1
  s_lshl_b32 s37, s37, 20
  s_xor_b32 s36, s36, s37
  v_xor_b32 v16, v80, v16
  v_xor_b32 v17, v81, v17
  v_xor_b32 v18, v82, v18
  v_xor_b32 v19, v83, v19
  v_xor_b32 v20, v80, v20
  v_xor_b32 v21, v81, v21
  v_xor_b32 v22, v82, v22
  v_xor_b32 v23, v83, v23
  v_xor_b32 v24, v80, v24
  v_xor_b32 v25, v81, v25
  v_xor_b32 v26, v82, v26
  v_xor_b32 v27, v83, v27
  v_xor_b32 v28, v80, v28
  v_xor_b32 v29, v81, v29
  v_xor_b32 v30, v82, v30
  v_xor_b32 v31, v83, v31
  v_or3_b32 v32, v16, v17, v18
  v_or3_b32 v32, v19, v20, v32
  v_or3_b32 v32, v21, v22, v32
  v_or3_b32 v32, v23, v24, v32
  v_or3_b32 v32, v25, v26, v32
  v_or3_b32 v32, v27, v28, v32
  v_or3_b32 v32, v29, v30, v32
  v_or_b32 v32, v31, v32
  v_and_b32 v32, 3, v32
  v_cmp_ne_u32 vcc, 0, v32
  s_cbranch_vccnz L_pq
  v_add_f32 v16, v16, v20
  v_add_f32 v24, v24, v28
  v_add_f32 v17, v17, v21
  v_add_f32 v25, v25, v29
  v_add_f32 v18, v18, v22
  v_add_f32 v26, v26, v30
  v_add_f32 v19, v19, v23
  v_add_f32 v27, v27, v31
  v_add_f32 v16, v16, v24
  v_add_f32 v17, v17, v25
  v_add_f32 v18, v18, v26
  v_add_f32 v19, v19, v27
  v_cvt_pk_bf16_f32 v16, v16, v17
  v_cvt_pk_bf16_f32 v17, v18, v19
  ds_write_b64 v3, v[16:17]
  ds_write_b32 v13, v61 offset:32
L_cons:
  v_lshrrev_b32 v3, 3, v0
  v_and_b32 v4, 6, v3
  v_and_b32 v5, 7, v0
  v_xor_b32 v4, v4, v5
  v_lshlrev_b32 v4, 4, v4
  v_mul_u32_u24 v3, 1152, v3
  v_add_u32 v3, v3, v4
  s_mov_b32 s51, 0x20000
  s_cmp_eq_u32 s32, 1
  s_cbranch_scc0 L_tc_f
  s_mov_b64 s[48:49], s[12:13]
  s_mov_b32 s50, 4718592
  s_lshl_b32 s54, s79, 2
  s_add_u32 s54, s54, s3
  s_mov_b32 s55, 0
  s_mov_b32 s36, s33
  s_branch L_tc_c
L_tc_f:
  s_mov_b64 s[48:49], s[18:19]
  s_and_b32 s54, s3, 1
  s_add_u32 s54, s54, 4
  s_lshr_b32 s36, s3, 1
  s_cmp_eq_u32 s32, 2
  s_cselect_b32 s54, s3, s54
  s_cselect_b32 s36, 0, s36
  s_add_u32 s36, s36, s33
  s_cmp_lt_u32 s36, 9
  s_cselect_b32 s50, 5308416, 0
  s_lshr_b32 s55, s54, 1
  s_mul_i32 s55, s55, 6
  s_and_b32 s37, s54, 1
  s_add_u32 s55, s55, s37
  s_mul_i32 s37, s28, 18
  s_add_u32 s55, s55, s37
  s_add_u32 s55, s55, 2
  s_mul_i32 s54, s54, 3
  s_add_u32 s54, s54, s37
  s_add_u32 s54, s54, 1
  s_lshr_b32 s54, s54, 1
L_tc_c:
  s_lshl_b32 s36, s36, 7
  s_mul_i32 s52, s54, 73728
  s_add_u32 s52, s52, s36
  s_mul_i32 s53, s55, 36864
  s_add_u32 s53, s53, s36
  s_mul_i32 s36, s3, 12288
  s_add_u32 s36, s36, 55296
  v_lshrrev_b32 v8, 2, v0
  v_and_b32 v9, 6, v8
  v_bfe_u32 v10, v0, 1, 1
  v_or_b32 v9, v9, v10
  v_lshlrev_b32 v9, 4, v9
  v_lshl_add_u32 v8, v8, 7, v9
  v_and_b32 v9, 1, v0
  v_lshl_add_u32 v8, v9, 3, v8
  v_add_u32 v8, s36, v8
  v_xor_b32 v9, 32, v8
  v_xor_b32 v10, 64, v8
  v_xor_b32 v11, 0x60, v8
  v_lshrrev_b32 v4, 4, v0
  v_lshlrev_b32 v4, 6, v4
  v_and_b32 v5, 3, v0
  v_lshl_add_u32 v4, v5, 4, v4
  v_bfe_u32 v5, v0, 2, 2
  s_lshl_b32 s37, s3, 10
  s_add_u32 s37, s37, 113984
  v_add_u32 v7, s37, v7
  v_lshl_add_u32 v15, s3, 2, v13
L_cq:
  ds_read_b32 v1, v13 offset:32
  s_add_u32 s59, s59, 1
  s_cmp_gt_u32 s59, 200000
  s_cbranch_scc1 L_exit
  s_waitcnt lgkmcnt(0)
  v_cmp_ne_u32 vcc, 0, v1
  s_cbranch_vccnz L_cq_ok
  s_sleep 4
  s_branch L_cq
L_cq_ok:
L_ct:
  ds_read_b32 v1, v15 offset:96
  s_add_u32 s59, s59, 1
  s_cmp_gt_u32 s59, 200000
  s_cbranch_scc1 L_exit
  s_waitcnt lgkmcnt(0)
  v_cmp_ne_u32 vcc, 0, v1
  s_cbranch_vccnz L_ct_ok
  s_sleep 4
  s_branch L_ct
L_ct_ok:
  ds_read_b32 v1, v13 offset:40
  s_waitcnt lgkmcnt(0)
  v_readfirstlane_b32 s47, v1
  s_and_b32 s47, s47, 1
  s_lshl_b32 s47, s47, 20
  s_cmp_eq_u32 s32, 1
  s_cbranch_scc1 L_consO
  s_lshl_b32 s40, s54, 11
  s_add_u32 s40, s40, 327680
  s_lshr_b32 s41, s55, 1
  s_lshl_b32 s41, s41, 11
  s_add_u32 s41, s41, 327680
  v_lshl_add_u32 v4, v5, 8, v4
  v_and_b32 v6, 3, v0
  v_lshlrev_b32 v35, 3, v6
  v_lshrrev_b32 v35, v35, s58
  v_bfe_u32 v32, v35, 0, 2
  v_bfe_u32 v33, v35, 2, 2
  v_bfe_u32 v34, v35, 4, 2
  v_bfe_u32 v35, v35, 6, 2
L_ht:
  ds_read_b32 v1, v13 offset:84
  s_add_u32 s59, s59, 1
  s_cmp_gt_u32 s59, 200000
  s_cbranch_scc1 L_exit
  s_waitcnt lgkmcnt(0)
  v_cmp_ne_u32 vcc, 0, v1
  s_cbranch_vccnz L_ht_ok
  s_sleep 4
  s_branch L_ht
L_ht_ok:
L_ph:
  buffer_load_dwordx4 v[16:19], v4, s[24:27], s40 offen offset:0 sc1
  buffer_load_dwordx4 v[20:23], v4, s[24:27], s40 offen offset:1024 sc1
  buffer_load_dwordx4 v[24:27], v4, s[24:27], s41 offen offset:0 sc1
  buffer_load_dwordx4 v[28:31], v4, s[24:27], s41 offen offset:1024 sc1
  s_add_u32 s59, s59, 1
  s_cmp_gt_u32 s59, 200000
  s_cbranch_scc1 L_exit
  s_xor_b32 s40, s40, s47
  s_xor_b32 s41, s41, s47
  s_waitcnt vmcnt(0)
  v_xor_b32 v16, v32, v16
  v_xor_b32 v17, v33, v17
  v_xor_b32 v18, v34, v18
  v_xor_b32 v19, v35, v19
  v_xor_b32 v20, v32, v20
  v_xor_b32 v21, v33, v21
  v_xor_b32 v22, v34, v22
  v_xor_b32 v23, v35, v23
  v_xor_b32 v24, v32, v24
  v_xor_b32 v25, v33, v25
  v_xor_b32 v26, v34, v26
  v_xor_b32 v27, v35, v27
  v_xor_b32 v28, v32, v28
  v_xor_b32 v29, v33, v29
  v_xor_b32 v30, v34, v30
  v_xor_b32 v31, v35, v31
  v_or3_b32 v40, v16, v17, v18
  v_or3_b32 v40, v19, v20, v40
  v_or3_b32 v40, v21, v22, v40
  v_or3_b32 v40, v23, v24, v40
  v_or3_b32 v40, v25, v26, v40
  v_or3_b32 v40, v27, v28, v40
  v_or3_b32 v40, v29, v30, v40
  v_or_b32 v40, v31, v40
  v_and_b32 v40, 3, v40
  v_cmp_ne_u32 vcc, 0, v40
  s_cbranch_vccnz L_ph
  v_add_f32 v16, v16, v20
  v_add_f32 v17, v17, v21
  v_add_f32 v18, v18, v22
  v_add_f32 v19, v19, v23
  v_add_f32 v24, v24, v28
  v_add_f32 v25, v25, v29
  v_add_f32 v26, v26, v30
  v_add_f32 v27, v27, v31
  v_cvt_pk_bf16_f32 v16, 0, v16
  v_cvt_pk_bf16_f32 v17, 0, v17
  v_cvt_pk_bf16_f32 v18, 0, v18
  v_cvt_pk_bf16_f32 v19, 0, v19
  v_cvt_pk_bf16_f32 v24, 0, v24
  v_cvt_pk_bf16_f32 v25, 0, v25
  v_cvt_pk_bf16_f32 v26, 0, v26
  v_cvt_pk_bf16_f32 v27, 0, v27
  v_mul_f32 v20, 0xbfb8aa3b, v16
  v_mul_f32 v21, 0xbfb8aa3b, v17
  v_mul_f32 v22, 0xbfb8aa3b, v18
  v_mul_f32 v23, 0xbfb8aa3b, v19
  v_mul_f32 v28, 0xbfb8aa3b, v24
  v_mul_f32 v29, 0xbfb8aa3b, v25
  v_mul_f32 v30, 0xbfb8aa3b, v26
  v_mul_f32 v31, 0xbfb8aa3b, v27
  v_exp_f32 v20, v20
  v_exp_f32 v21, v21
  v_exp_f32 v22, v22
  v_exp_f32 v23, v23
  v_exp_f32 v28, v28
  v_exp_f32 v29, v29
  v_exp_f32 v30, v30
  v_exp_f32 v31, v31
  v_add_f32 v20, 1.0, v20
  v_add_f32 v21, 1.0, v21
  v_add_f32 v22, 1.0, v22
  v_add_f32 v23, 1.0, v23
  v_add_f32 v28, 1.0, v28
  v_add_f32 v29, 1.0, v29
  v_add_f32 v30, 1.0, v30
  v_add_f32 v31, 1.0, v31
  v_rcp_f32 v20, v20
  v_rcp_f32 v21, v21
  v_rcp_f32 v22, v22
  v_rcp_f32 v23, v23
  v_rcp_f32 v28, v28
  v_rcp_f32 v29, v29
  v_rcp_f32 v30, v30
  v_rcp_f32 v31, v31
  v_mul_f32 v16, v16, v20
  v_mul_f32 v17, v17, v21
  v_mul_f32 v18, v18, v22
  v_mul_f32 v19, v19, v23
  v_mul_f32 v24, v24, v28
  v_mul_f32 v25, v25, v29
  v_mul_f32 v26, v26, v30
  v_mul_f32 v27, v27, v31
  v_cvt_pk_bf16_f32 v16, v16, v17
  v_cvt_pk_bf16_f32 v17, v18, v19
  v_cvt_pk_bf16_f32 v18, v24, v25
  v_cvt_pk_bf16_f32 v19, v26, v27
  v_mov_b32_dpp v20, v16 quad_perm:[0,0,0,0] row_mask:0xf bank_mask:0xf
  v_mov_b32_dpp v21, v17 quad_perm:[0,0,0,0] row_mask:0xf bank_mask:0xf
  v_mov_b32_dpp v22, v16 quad_perm:[1,1,1,1] row_mask:0xf bank_mask:0xf
  v_mov_b32_dpp v23, v17 quad_perm:[1,1,1,1] row_mask:0xf bank_mask:0xf
  v_mov_b32_dpp v24, v16 quad_perm:[2,2,2,2] row_mask:0xf bank_mask:0xf
  v_mov_b32_dpp v25, v17 quad_perm:[2,2,2,2] row_mask:0xf bank_mask:0xf
  v_mov_b32_dpp v26, v16 quad_perm:[3,3,3,3] row_mask:0xf bank_mask:0xf
  v_mov_b32_dpp v27, v17 quad_perm:[3,3,3,3] row_mask:0xf bank_mask:0xf
  v_mov_b32_dpp v28, v18 quad_perm:[0,0,0,0] row_mask:0xf bank_mask:0xf
  v_mov_b32_dpp v29, v19 quad_perm:[0,0,0,0] row_mask:0xf bank_mask:0xf
  v_mov_b32_dpp v30, v18 quad_perm:[1,1,1,1] row_mask:0xf bank_mask:0xf
  v_mov_b32_dpp v31, v19 quad_perm:[1,1,1,1] row_mask:0xf bank_mask:0xf
  s_bitcmp1_b32 s55, 0
  s_cbranch_scc0 L_h0
  v_mov_b32_dpp v28, v18 quad_perm:[2,2,2,2] row_mask:0xf bank_mask:0xf
  v_mov_b32_dpp v29, v19 quad_perm:[2,2,2,2] row_mask:0xf bank_mask:0xf
  v_mov_b32_dpp v30, v18 quad_perm:[3,3,3,3] row_mask:0xf bank_mask:0xf
  v_mov_b32_dpp v31, v19 quad_perm:[3,3,3,3] row_mask:0xf bank_mask:0xf
L_h0:
  ds_read_b64_tr_b16 v[64:65], v8 offset:0
  ds_read_b64_tr_b16 v[66:67], v8 offset:2048
  ds_read_b64_tr_b16 v[68:69], v9 offset:0
  ds_read_b64_tr_b16 v[70:71], v9 offset:2048
  ds_read_b64_tr_b16 v[72:73], v10 offset:0
  ds_read_b64_tr_b16 v[74:75], v10 offset:2048
  ds_read_b64_tr_b16 v[76:77], v11 offset:0
  ds_read_b64_tr_b16 v[78:79], v11 offset:2048
  s_waitcnt lgkmcnt(0)
  v_mfma_f32_16x16x32_bf16 v[44:47], v[20:23], v[64:67], 0
  v_mfma_f32_16x16x32_bf16 v[48:51], v[20:23], v[68:71], 0
  v_mfma_f32_16x16x32_bf16 v[52:55], v[20:23], v[72:75], 0
  v_mfma_f32_16x16x32_bf16 v[56:59], v[20:23], v[76:79], 0
  s_cmp_lg_u32 s3, 3
  s_cbranch_scc1 L_spf_e
  v_lshrrev_b32 v40, 5, v0
  v_lshlrev_b32 v41, 8, v40
  v_lshlrev_b32 v40, 4, v40
  v_add_u32 v40, 109824, v40
  s_lshl_b32 s37, s30, 9
  s_lshl_b32 s38, s31, 4
  s_add_u32 s37, s37, s38
  s_add_u32 s37, s37, 32768
  s_add_u32 s38, s37, 1048576
L_spf:
  ds_read_b128 v[32:35], v40 offset:32
  ds_read_b128 v[36:39], v40
  s_add_u32 s59, s59, 1
  s_cmp_gt_u32 s59, 200000
  s_cbranch_scc1 L_exit
  s_waitcnt lgkmcnt(0)
  v_and_b32 v42, v32, v33
  v_and_b32 v43, v34, v35
  v_and_b32 v42, v42, v43
  v_and_b32 v42, 1, v42
  v_cmp_eq_u32 vcc, 0, v42
  s_cbranch_vccz L_spf_k
  s_sleep 4
  s_branch L_spf
L_spf_k:
  v_add_f32 v32, v32, v33
  v_add_f32 v34, v34, v35
  v_max3_f32 v36, v36, v37, v38
  v_add_f32 v33, v32, v34
  v_max_f32 v32, v36, v39
  v_bfi_b32 v35, v61, s63, v33
  v_bfi_b32 v34, v61, s62, v32
  v_bfi_b32 v33, v61, s61, v33
  v_bfi_b32 v32, v61, s60, v32
  s_mov_b32 exec_lo, 1
  s_mov_b32 exec_hi, 1
  s_cmp_eq_u32 s47, 0
  buffer_store_dwordx4 v[32:35], v41, s[24:27], s37 offen
  s_cbranch_scc1 L_spf_f
  buffer_store_dwordx4 v[32:35], v41, s[24:27], s38 offen sc1
L_spf_f:
  s_mov_b64 exec, -1
L_spf_e:
  s_cmp_lg_u32 s3, 1
  s_cbranch_scc1 L_fs2
  v_and_b32 v5, 0xf0, v2
  s_lshl_b32 s40, s30, 9
  s_add_u32 s40, s40, 32768
L_fs0:
  ds_read_b32 v1, v13 offset:36
  s_add_u32 s59, s59, 1
  s_cmp_gt_u32 s59, 200000
  s_cbranch_scc1 L_exit
  s_waitcnt lgkmcnt(0)
  v_cmp_ne_u32 vcc, 0, v1
  s_cbranch_vccnz L_fs0_ok
  s_sleep 4
  s_branch L_fs0
L_fs0_ok:
L_fs1:
  buffer_load_dwordx4 v[32:35], v5, s[24:27], s40 offen sc1
  s_add_u32 s59, s59, 1
  s_cmp_gt_u32 s59, 200000
  s_cbranch_scc1 L_exit
  s_xor_b32 s40, s40, s47
  s_waitcnt vmcnt(0)
  v_xor_b32 v32, s60, v32
  v_xor_b32 v33, s61, v33
  v_xor_b32 v34, s62, v34
  v_xor_b32 v35, s63, v35
  v_or3_b32 v36, v32, v33, v34
  v_or_b32 v36, v35, v36
  v_and_b32 v36, 0xff, v36
  v_cmp_ne_u32 vcc, 0, v36
  s_cbranch_vccnz L_fs1
L_fs2:
L_gf:
  ds_read_b32 v1, v15 offset:48
  s_add_u32 s59, s59, 1
  s_cmp_gt_u32 s59, 200000
  s_cbranch_scc1 L_exit
  s_waitcnt lgkmcnt(0)
  v_cmp_ne_u32 vcc, 0, v1
  s_cbranch_vccnz L_gf_ok
  s_sleep 1
  s_branch L_gf
L_gf_ok:
  s_add_u32 m0, s36, 6144
  s_add_u32 s37, s52, 55296
  buffer_load_dwordx4 v3, s[48:51], s37 offen nt lds
  s_add_u32 m0, s36, 7168
  s_add_u32 s37, s52, 64512
  buffer_load_dwordx4 v3, s[48:51], s37 offen nt lds
  s_add_u32 m0, s36, 8192
  s_add_u32 s37, s53, 0
  buffer_load_dwordx4 v3, s[48:51], s37 offen nt lds
  s_add_u32 m0, s36, 9216
  s_add_u32 s37, s53, 9216
  buffer_load_dwordx4 v3, s[48:51], s37 offen nt lds
  s_add_u32 m0, s36, 10240
  s_add_u32 s37, s53, 18432
  buffer_load_dwordx4 v3, s[48:51], s37 offen nt lds
  s_add_u32 m0, s36, 11264
  s_add_u32 s37, s53, 27648
  buffer_load_dwordx4 v3, s[48:51], s37 offen nt lds
  s_barrier
  s_waitcnt vmcnt(4)
  ds_read_b64_tr_b16 v[80:81], v8 offset:4096
  ds_read_b64_tr_b16 v[82:83], v8 offset:6144
  ds_read_b64_tr_b16 v[84:85], v9 offset:4096
  ds_read_b64_tr_b16 v[86:87], v9 offset:6144
  ds_read_b64_tr_b16 v[88:89], v10 offset:4096
  ds_read_b64_tr_b16 v[90:91], v10 offset:6144
  ds_read_b64_tr_b16 v[92:93], v11 offset:4096
  ds_read_b64_tr_b16 v[94:95], v11 offset:6144
  s_waitcnt lgkmcnt(6)
  v_mfma_f32_16x16x32_bf16 v[44:47], v[24:27], v[80:83], v[44:47]
  s_waitcnt lgkmcnt(4)
  v_mfma_f32_16x16x32_bf16 v[48:51], v[24:27], v[84:87], v[48:51]
  s_waitcnt lgkmcnt(2)
  v_mfma_f32_16x16x32_bf16 v[52:55], v[24:27], v[88:91], v[52:55]
  s_waitcnt lgkmcnt(0)
  v_mfma_f32_16x16x32_bf16 v[56:59], v[24:27], v[92:95], v[56:59]
  s_waitcnt vmcnt(0)
  ds_read_b64_tr_b16 v[96:97], v8 offset:8192
  ds_read_b64_tr_b16 v[98:99], v8 offset:10240
  ds_read_b64_tr_b16 v[100:101], v9 offset:8192
  ds_read_b64_tr_b16 v[102:103], v9 offset:10240
  ds_read_b64_tr_b16 v[104:105], v10 offset:8192
  ds_read_b64_tr_b16 v[106:107], v10 offset:10240
  ds_read_b64_tr_b16 v[108:109], v11 offset:8192
  ds_read_b64_tr_b16 v[110:111], v11 offset:10240
  s_waitcnt lgkmcnt(6)
  v_mfma_f32_16x16x32_bf16 v[44:47], v[28:31], v[96:99], v[44:47]
  s_waitcnt lgkmcnt(4)
  v_mfma_f32_16x16x32_bf16 v[48:51], v[28:31], v[100:103], v[48:51]
  s_waitcnt lgkmcnt(2)
  v_mfma_f32_16x16x32_bf16 v[52:55], v[28:31], v[104:107], v[52:55]
  s_waitcnt lgkmcnt(0)
  v_mfma_f32_16x16x32_bf16 v[56:59], v[28:31], v[108:111], v[56:59]
  s_branch L_mmend
L_consO:
  v_lshl_add_u32 v4, v5, 12, v4
  v_and_b32 v5, 0xf0, v2
  s_lshl_b32 s41, s30, 14
  s_lshl_b32 s39, s3, 8
  s_add_u32 s41, s41, s39
  s_add_u32 s41, s41, 65536
  s_lshl_b32 s40, s30, 9
  s_lshr_b32 s39, s3, 1
  s_lshl_b32 s39, s39, 8
  s_add_u32 s40, s40, s39
  s_add_u32 s40, s40, 32768
  s_cmp_lg_u32 s3, 3
  s_cbranch_scc1 L_spo_e
  v_lshrrev_b32 v40, 5, v0
  v_lshlrev_b32 v41, 8, v40
  v_lshlrev_b32 v40, 4, v40
  v_add_u32 v40, 109824, v40
  s_lshl_b32 s37, s30, 9
  s_lshl_b32 s38, s31, 4
  s_add_u32 s37, s37, s38
  s_add_u32 s37, s37, 32768
  s_add_u32 s38, s37, 1048576
L_spo:
  ds_read_b128 v[32:35], v40 offset:32
  ds_read_b128 v[36:39], v40
  s_add_u32 s59, s59, 1
  s_cmp_gt_u32 s59, 200000
  s_cbranch_scc1 L_exit
  s_waitcnt lgkmcnt(0)
  v_and_b32 v42, v32, v33
  v_and_b32 v43, v34, v35
  v_and_b32 v42, v42, v43
  v_and_b32 v42, 1, v42
  v_cmp_eq_u32 vcc, 0, v42
  s_cbranch_vccz L_spo_k
  s_sleep 4
  s_branch L_spo
L_spo_k:
  v_add_f32 v32, v32, v33
  v_add_f32 v34, v34, v35
  v_max3_f32 v36, v36, v37, v38
  v_add_f32 v33, v32, v34
  v_max_f32 v32, v36, v39
  v_bfi_b32 v35, v61, s63, v33
  v_bfi_b32 v34, v61, s62, v32
  v_bfi_b32 v33, v61, s61, v33
  v_bfi_b32 v32, v61, s60, v32
  s_mov_b32 exec_lo, 1
  s_mov_b32 exec_hi, 1
  s_cmp_eq_u32 s47, 0
  buffer_store_dwordx4 v[32:35], v41, s[24:27], s37 offen
  s_cbranch_scc1 L_spo_f
  buffer_store_dwordx4 v[32:35], v41, s[24:27], s38 offen sc1
L_spo_f:
  s_mov_b64 exec, -1
L_spo_e:
L_st:
  ds_read_b32 v1, v13 offset:36
  s_add_u32 s59, s59, 1
  s_cmp_gt_u32 s59, 200000
  s_cbranch_scc1 L_exit
  s_waitcnt lgkmcnt(0)
  v_cmp_ne_u32 vcc, 0, v1
  s_cbranch_vccnz L_st_ok
  s_sleep 4
  s_branch L_st
L_st_ok:
L_ps:
  buffer_load_dwordx4 v[32:35], v5, s[24:27], s40 offen sc1
  s_add_u32 s59, s59, 1
  s_cmp_gt_u32 s59, 200000
  s_cbranch_scc1 L_exit
  s_xor_b32 s40, s40, s47
  s_waitcnt vmcnt(0)
  v_xor_b32 v32, s60, v32
  v_xor_b32 v33, s61, v33
  v_xor_b32 v34, s62, v34
  v_xor_b32 v35, s63, v35
  v_or3_b32 v36, v32, v33, v34
  v_or_b32 v36, v35, v36
  v_and_b32 v36, 0xff, v36
  v_cmp_ne_u32 vcc, 0, v36
  s_cbranch_vccnz L_ps
  v_max_f32_dpp v36, v32, v32 quad_perm:[1,0,3,2] row_mask:0xf bank_mask:0xf
  s_nop 1
  v_max_f32_dpp v36, v36, v36 quad_perm:[2,3,0,1] row_mask:0xf bank_mask:0xf
  v_sub_f32 v36, v32, v36
  v_mul_f32 v36, s57, v36
  v_exp_f32 v36, v36
  s_nop 0
  v_mul_f32 v37, v36, v33
  s_nop 1
  v_add_f32_dpp v37, v37, v37 quad_perm:[1,0,3,2] row_mask:0xf bank_mask:0xf
  s_nop 1
  v_add_f32_dpp v37, v37, v37 quad_perm:[2,3,0,1] row_mask:0xf bank_mask:0xf
  v_rcp_f32 v37, v37
  s_nop 0
  v_mul_f32 v36, v36, v37
  s_nop 1
  v_mov_b32_dpp v32, v36 quad_perm:[0,0,0,0] row_mask:0xf bank_mask:0xf
  v_mov_b32_dpp v33, v36 quad_perm:[1,1,1,1] row_mask:0xf bank_mask:0xf
  v_mov_b32_dpp v34, v36 quad_perm:[2,2,2,2] row_mask:0xf bank_mask:0xf
  v_mov_b32_dpp v35, v36 quad_perm:[3,3,3,3] row_mask:0xf bank_mask:0xf
  v_and_b32 v38, 3, v0
  v_lshlrev_b32 v38, 3, v38
  v_lshrrev_b32 v38, v38, s58
  v_and_b32 v38, 0xff, v38
  s_mov_b64 s[42:43], -1
  v_xor_b32 v38, 2, v38
L_go:
  ds_read_b32 v1, v15 offset:48
  s_add_u32 s59, s59, 1
  s_cmp_gt_u32 s59, 200000
  s_cbranch_scc1 L_exit
  s_waitcnt lgkmcnt(0)
  v_cmp_ne_u32 vcc, 0, v1
  s_cbranch_vccnz L_go_ok
  s_sleep 1
  s_branch L_go
L_go_ok:
  s_add_u32 m0, s36, 2048
  s_add_u32 s37, s52, 18432
  buffer_load_dwordx4 v3, s[48:51], s37 offen nt lds
  s_add_u32 m0, s36, 3072
  s_add_u32 s37, s52, 27648
  buffer_load_dwordx4 v3, s[48:51], s37 offen nt lds
  s_add_u32 m0, s36, 4096
  s_add_u32 s37, s52, 36864
  buffer_load_dwordx4 v3, s[48:51], s37 offen nt lds
  s_add_u32 m0, s36, 5120
  s_add_u32 s37, s52, 46080
  buffer_load_dwordx4 v3, s[48:51], s37 offen nt lds
  s_add_u32 m0, s36, 6144
  s_add_u32 s37, s52, 55296
  buffer_load_dwordx4 v3, s[48:51], s37 offen nt lds
  s_add_u32 m0, s36, 7168
  s_add_u32 s37, s52, 64512
  buffer_load_dwordx4 v3, s[48:51], s37 offen nt lds
  s_barrier
L_go2:
  ds_read_b32 v1, v13 offset:44
  s_add_u32 s59, s59, 1
  s_cmp_gt_u32 s59, 200000
  s_cbranch_scc1 L_exit
  s_waitcnt lgkmcnt(0)
  v_cmp_ne_u32 vcc, 0, v1
  s_cbranch_vccnz L_go2_ok
  s_sleep 0
  s_branch L_go2
L_go2_ok:
  buffer_load_dwordx4 v[128:131], v4, s[24:27], s41 offen offset:0 sc1
  buffer_load_dwordx4 v[132:135], v4, s[24:27], s41 offen offset:1024 sc1
  buffer_load_dwordx4 v[136:139], v4, s[24:27], s41 offen offset:2048 sc1
  buffer_load_dwordx4 v[140:143], v4, s[24:27], s41 offen offset:3072 sc1
  s_xor_b32 s41, s41, s47
  s_waitcnt vmcnt(8)
  ds_read_b64_tr_b16 v[64:65], v8 offset:0
  ds_read_b64_tr_b16 v[66:67], v8 offset:2048
  ds_read_b64_tr_b16 v[68:69], v9 offset:0
  ds_read_b64_tr_b16 v[70:71], v9 offset:2048
  ds_read_b64_tr_b16 v[72:73], v10 offset:0
  ds_read_b64_tr_b16 v[74:75], v10 offset:2048
  ds_read_b64_tr_b16 v[76:77], v11 offset:0
  ds_read_b64_tr_b16 v[78:79], v11 offset:2048
  s_waitcnt vmcnt(4)
  ds_read_b64_tr_b16 v[80:81], v8 offset:4096
  ds_read_b64_tr_b16 v[82:83], v8 offset:6144
  ds_read_b64_tr_b16 v[84:85], v9 offset:4096
  ds_read_b64_tr_b16 v[86:87], v9 offset:6144
  ds_read_b64_tr_b16 v[88:89], v10 offset:4096
  ds_read_b64_tr_b16 v[90:91], v10 offset:6144
  ds_read_b64_tr_b16 v[92:93], v11 offset:4096
  ds_read_b64_tr_b16 v[94:95], v11 offset:6144
L_po:
L_po1:
  s_waitcnt vmcnt(0)
  v_xor_b32 v128, v38, v128
  v_xor_b32 v132, v38, v132
  v_xor_b32 v136, v38, v136
  v_xor_b32 v140, v38, v140
  v_or3_b32 v37, v128, v132, v136
  v_bitop3_b32 v37, v37, v140, v61 bitop3:0xa8
  v_cmp_ne_u32 vcc, 0, v37
  s_wqm_b64 vcc, vcc
  s_andn2_b64 exec, s[42:43], vcc
  s_cbranch_execz L_pn0
  v_pk_mul_f32 v[16:17], v[128:129], v[32:33] op_sel_hi:[1,0]
  v_pk_mul_f32 v[18:19], v[130:131], v[32:33] op_sel_hi:[1,0]
  v_pk_fma_f32 v[16:17], v[132:133], v[32:33], v[16:17] op_sel:[0,1,0]
  v_pk_fma_f32 v[18:19], v[134:135], v[32:33], v[18:19] op_sel:[0,1,0]
  v_pk_fma_f32 v[16:17], v[136:137], v[34:35], v[16:17] op_sel_hi:[1,0,1]
  v_pk_fma_f32 v[18:19], v[138:139], v[34:35], v[18:19] op_sel_hi:[1,0,1]
  v_pk_fma_f32 v[16:17], v[140:141], v[34:35], v[16:17] op_sel:[0,1,0]
  v_pk_fma_f32 v[18:19], v[142:143], v[34:35], v[18:19] op_sel:[0,1,0]
  s_and_b64 s[42:43], s[42:43], vcc
  s_cbranch_scc0 L_pd
L_pn0:
  s_mov_b64 exec, s[42:43]
  s_add_u32 s59, s59, 1
  s_cmp_gt_u32 s59, 200000
  s_cbranch_scc1 L_exit
  buffer_load_dwordx4 v[128:131], v4, s[24:27], s41 offen offset:0 sc1
  buffer_load_dwordx4 v[132:135], v4, s[24:27], s41 offen offset:1024 sc1
  buffer_load_dwordx4 v[136:139], v4, s[24:27], s41 offen offset:2048 sc1
  buffer_load_dwordx4 v[140:143], v4, s[24:27], s41 offen offset:3072 sc1
  s_xor_b32 s41, s41, s47
  s_branch L_po
L_pd:
  s_mov_b64 exec, -1
  v_cvt_pk_bf16_f32 v16, v16, v17
  v_cvt_pk_bf16_f32 v17, v18, v19
  s_waitcnt lgkmcnt(0)
  v_mov_b32_dpp v20, v16 quad_perm:[0,0,0,0] row_mask:0xf bank_mask:0xf
  v_mov_b32_dpp v21, v17 quad_perm:[0,0,0,0] row_mask:0xf bank_mask:0xf
  v_mov_b32_dpp v22, v16 quad_perm:[1,1,1,1] row_mask:0xf bank_mask:0xf
  v_mov_b32_dpp v23, v17 quad_perm:[1,1,1,1] row_mask:0xf bank_mask:0xf
  v_mov_b32_dpp v24, v16 quad_perm:[2,2,2,2] row_mask:0xf bank_mask:0xf
  v_mov_b32_dpp v25, v17 quad_perm:[2,2,2,2] row_mask:0xf bank_mask:0xf
  v_mfma_f32_16x16x32_bf16 v[44:47], v[20:23], v[64:67], 0
  v_mov_b32_dpp v26, v16 quad_perm:[3,3,3,3] row_mask:0xf bank_mask:0xf
  v_mov_b32_dpp v27, v17 quad_perm:[3,3,3,3] row_mask:0xf bank_mask:0xf
  v_mfma_f32_16x16x32_bf16 v[48:51], v[20:23], v[68:71], 0
  s_nop 0
  v_mfma_f32_16x16x32_bf16 v[44:47], v[24:27], v[80:83], v[44:47]
  v_mfma_f32_16x16x32_bf16 v[48:51], v[24:27], v[84:87], v[48:51]
  v_mfma_f32_16x16x32_bf16 v[52:55], v[20:23], v[72:75], 0
  v_mfma_f32_16x16x32_bf16 v[56:59], v[20:23], v[76:79], 0
  v_mfma_f32_16x16x32_bf16 v[52:55], v[24:27], v[88:91], v[52:55]
  v_mfma_f32_16x16x32_bf16 v[56:59], v[24:27], v[92:95], v[56:59]
L_mmend:
  s_cmp_eq_u32 s3, 3
  s_nop 2
  ds_write2st64_b32 v7, v44, v48 offset0:0 offset1:1
  s_nop 2
  ds_write2st64_b32 v7, v52, v56 offset0:2 offset1:3
  s_waitcnt lgkmcnt(0)
  s_barrier
  s_cbranch_scc0 L_fin
  ds_read2st64_b32 v[12:13], v119 offset0:0 offset1:4
  ds_read2st64_b32 v[14:15], v119 offset0:8 offset1:12
  s_branch L_final2
L_fin:
L_exit:
  s_endpgm
.fill (16640 - (. - parallel_sum__sliding_block_cached__dense_activation_silu__decode_kernel)) / 4, 4, 0xbf810000
.section .rodata,"a"
.p2align 6
.amdhsa_kernel parallel_sum__sliding_block_cached__dense_activation_silu__decode_kernel
  .amdhsa_next_free_vgpr 256
  .amdhsa_next_free_sgpr 102
  .amdhsa_accum_offset 256
  .amdhsa_group_segment_fixed_size 0
  .amdhsa_kernarg_size 88
  .amdhsa_user_sgpr_count 2
  .amdhsa_user_sgpr_kernarg_segment_ptr 1
  .amdhsa_system_sgpr_workgroup_id_x 1
  .amdhsa_float_denorm_mode_32 3
.end_amdhsa_kernel
```
